```python
import torch

def _softmax(x, axis=-1):
    return torch.softmax(x, dim=axis)

def _gelu(x):
    return torch.nn.functional.gelu(x, approximate='tanh')

def _silu(x):
    return torch.nn.functional.silu(x)

def _sigmoid(x):
    return torch.sigmoid(x)

def _layernorm(x, axis=-1, eps=1e-05):
    m = x.mean(dim=axis, keepdim=True)
    v = x.var(dim=axis, keepdim=True, unbiased=False)
    return (x - m) / torch.sqrt(v + eps)

def _scatter_add(tgt, idx, src, axis=0):
    return tgt.clone().index_add_(axis, idx, src)

def _segment_sum(src, seg, n):
    out = torch.zeros((n,) + src.shape[1:], dtype=src.dtype)
    return out.index_add_(0, seg, src)

def _pad(x, pw):
    flat = tuple((v for pair in reversed(pw) for v in pair))
    return torch.nn.functional.pad(x, flat)
kernel_name = 'adaLN_cond__gqa_block_cached__geglu_ffn__decode'

def setup_inputs():

    _w = lambda a: (lambda t: t.to(torch.bfloat16) if t.is_floating_point() else t)(torch.as_tensor(a))

    def _A_setup():
        B, Sq, D = (4, 1, 1024)
        Hq, Hkv, Sk, Dh = (32, 4, 16384, 128)
        assert Hq % Hkv == 0, (Hq, Hkv)
        return {'x': _w((lambda *s: torch.randn(*s, dtype=torch.bfloat16) * 0.1)(B, Sq, D)), 'k_cache': _w((lambda *s: torch.randn(*s, dtype=torch.bfloat16) * 0.8)(B, Hkv, Sk, Dh)), 'v_cache': _w((lambda *s: torch.randn(*s, dtype=torch.bfloat16) * 0.8)(B, Hkv, Sk, Dh)), 'wq': _w((lambda *s: torch.randn(*s, dtype=torch.bfloat16) * 0.8)(D, Hq * Dh) * D ** (-0.5)), 'wo': _w((lambda *s: torch.randn(*s, dtype=torch.bfloat16) * 0.8)(Hq * Dh, D) * (Hq * Dh) ** (-0.5))}
    _A_in = _A_setup()

    def _B_setup():
        B, S, D, F = (4, 1, 1024, 3584)
        return {'x': _w((lambda *s: torch.randn(*s, dtype=torch.bfloat16) * 0.1)(B, S, D)), 'w_gate': _w((lambda *s: torch.randn(*s, dtype=torch.bfloat16) * 0.1)(D, F)), 'w_up': _w((lambda *s: torch.randn(*s, dtype=torch.bfloat16) * 0.1)(D, F)), 'w_down': _w((lambda *s: torch.randn(*s, dtype=torch.bfloat16) * 0.1)(F, D))}
    _B_in = _B_setup()
    return {'A_x': _A_in['x'], 'A_k_cache': _A_in['k_cache'], 'A_v_cache': _A_in['v_cache'], 'A_wq': _A_in['wq'], 'A_wo': _A_in['wo'], 'B_x': _B_in['x'], 'B_w_gate': _B_in['w_gate'], 'B_w_up': _B_in['w_up'], 'B_w_down': _B_in['w_down'], 'c': _w((lambda *s: torch.randn(*s, dtype=torch.bfloat16) * 0.4)(4, 1024) * 8.0), 'w_mod': _w((lambda *s: torch.randn(*s, dtype=torch.bfloat16) * 0.4)(1024, 6 * 1024) * 1024 ** (-0.5) * 8.0)}

def reference(A_x, A_k_cache, A_v_cache, A_wq, A_wo, B_x, B_w_gate, B_w_up, B_w_down, c, w_mod):

    def _A_ref(x, k_cache, v_cache, wq, wo):
        B, Sq, D = x.shape
        Hq, Dh = (32, 128)
        Hkv = k_cache.shape[1]
        rep = Hq // Hkv
        q = (lambda x, *d: x.permute(*d))((x @ wq).reshape(B, Sq, Hq, Dh), 0, 2, 1, 3)
        k = (lambda x, n, axis: torch.repeat_interleave(x, n, dim=axis))(k_cache, rep, axis=1)
        v = (lambda x, n, axis: torch.repeat_interleave(x, n, dim=axis))(v_cache, rep, axis=1)
        scores = torch.einsum('bhqd,bhkd->bhqk', q, k) * Dh ** (-0.5)
        p = _softmax(scores, axis=-1)
        o = torch.einsum('bhqk,bhkd->bhqd', p, v)
        return (lambda x, *d: x.permute(*d))(o, 0, 2, 1, 3).reshape(B, Sq, Hq * Dh) @ wo

    def _B_ref(x, w_gate, w_up, w_down):
        return _gelu(x @ w_gate) * (x @ w_up) @ w_down
    x = A_x
    mod = (_silu(c) @ w_mod).reshape(c.shape[0], 6, 1, -1)
    sa, ca, ga, sb, cb, gb = (mod[:, 0].clone(), mod[:, 1].clone(), mod[:, 2].clone(), mod[:, 3].clone(), mod[:, 4].clone(), mod[:, 5].clone())
    h = _layernorm(x, axis=-1) * (1 + ca) + sa
    x = x + ga * _A_ref(h, A_k_cache, A_v_cache, A_wq, A_wo)
    h = _layernorm(x, axis=-1) * (1 + cb) + sb
    x = x + gb * _B_ref(h, B_w_gate, B_w_up, B_w_down)
    return x
```

```asm
; @launch grid=(256,1,1) block=(640,1,1) lds=163840
.amdgcn_target "amdgcn-amd-amdhsa--gfx950"
.text
.globl adaLN_cond__gqa_block_cached__geglu_ffn__decode_kernel
.p2align 8
.type adaLN_cond__gqa_block_cached__geglu_ffn__decode_kernel,@function
adaLN_cond__gqa_block_cached__geglu_ffn__decode_kernel:
L_first:
    s_cmp_ge_u32 s2, 256
    s_cbranch_scc1 L_end
    s_load_dwordx16 s[16:31], s[0:1], 0
    s_load_dwordx8 s[32:39], s[0:1], 64
    s_load_dwordx4 s[40:43], s[0:1], 96
    s_getpc_b64 s[46:47]
L_pc0:
    v_lshlrev_b32 v1, 5, v0
    v_min_u32 v1, L_last-L_pc0, v1
    global_load_dword v157, v1, s[46:47]
L_nol2:
    v_readfirstlane_b32 s3, v0
    s_and_b32 s4, s2, 7
    s_lshr_b32 s5, s2, 3
    s_lshr_b32 s3, s3, 6
    s_cbranch_scc1 L_notloader
    s_setprio 3
    s_lshl_b32 s57, s4, 8
    s_and_b32 s49, s5, 7
    s_lshl_b32 s49, s49, 20
    s_lshr_b32 s50, s5, 3
    s_lshl2_add_u32 s50, s4, s50
    s_lshl_b32 s50, s50, 8
    s_add_u32 s56, s49, s50
    s_and_b32 s49, s5, 3
    s_mulk_i32 s49, 0x600
    s_lshr_b32 s50, s5, 2
    s_add_u32 s49, s49, s50
    s_lshl_b32 s49, s49, 11
    s_add_u32 s49, s49, s57
    s_lshl_b32 s11, 1, 17
    s_cmp_ge_u32 s5, 24
    s_cselect_b32 s12, s56, s49
    s_cselect_b32 s44, 12, 4
    s_cselect_b32 s50, 8, 12
    s_lshl_b32 s10, s50, 20
    s_lshl_b32 s13, s50, 12
    s_lshl_b32 s50, s50, 10
    s_lshl_b32 m0, s44, 13
    v_lshrrev_b32 v6, 4, v0
    v_and_b32 v7, 15, v0
    v_lshlrev_b32 v11, 1, v6
    v_xor_b32 v7, v7, v11
    v_lshlrev_b32 v7, 4, v7
    v_mad_u32_u24 v1, v6, s50, v7
    v_xor_b32 v2, 0x80, v1
    s_mov_b32 s49, 7
    s_cmp_ge_u32 s5, 24
    s_waitcnt lgkmcnt(0)
    s_cselect_b64 s[8:9], s[22:23], s[36:37]
L_ld_0:
    buffer_load_dwordx4 v1, s[8:11], s12 offen nt lds
    s_addk_i32 m0, 0x400
    s_add_u32 s12, s12, s13
    buffer_load_dwordx4 v2, s[8:11], s12 offen nt lds
    s_addk_i32 m0, 0x400
    s_add_u32 s12, s12, s13
    s_sub_u32 s49, s49, 1
    s_cbranch_scc0 L_ld_0
    s_mov_b32 s11, 0x20000
    s_sub_u32 s44, s44, 2
    s_mov_b32 s48, 1048576
    s_mov_b32 s53, 0
    s_lshl_b32 s52, s13, 2
    v_mul_u32_u24 v15, s52, v0
    v_add_u32 v15, s12, v15
    s_mov_b32 s61, 1
    s_cmp_ge_u32 s5, 24
    s_cselect_b32 s51, 1, 0
    v_xor_b32 v10, 0x80, v7
    v_lshlrev_b32 v5, 2, v0
    v_mov_b32 v3, 0
    v_mov_b32 v14, s51
    v_and_b32 v4, 28, v5
    ds_write_b32 v5, v3 offset:0
    ds_write_b32 v5, v3 offset:256
    ds_write_b32 v3, v14 offset:288
    s_waitcnt lgkmcnt(0)
    s_barrier
    s_cbranch_scc1 L_ld_q
    s_mov_b32 s15, 8
    s_call_b64 s[46:47], L_loopM
    s_mov_b32 s12, s56
    v_mul_u32_u24 v15, 131072, v0
    v_add_u32 v15, s12, v15
    s_mov_b32 s8, s22
    s_mov_b32 s9, s23
    v_readlane_b32 s12, v15, 0
    s_mov_b32 s61, 1
    s_mov_b32 s10, 8388608
    s_mov_b32 s13, 32768
    v_mul_u32_u24 v11, 8192, v6
    v_add_u32 v1, v11, v7
    v_add_u32 v2, v11, v10
L_ld_q:
    s_mov_b32 s15, 12
    s_call_b64 s[46:47], L_loopM
L_ld_k:
    s_lshr_b32 s49, s5, 4
    s_lshl1_add_u32 s49, s4, s49
    s_and_b32 s50, s49, 3
    s_lshr_b32 s49, s49, 2
    s_lshl2_add_u32 s49, s50, s49
    s_lshl_b32 s49, s49, 22
    s_bitcmp1_b32 s5, 0
    s_cselect_b32 s50, 1343488, 0
    s_xor_b32 s49, s49, s50
    s_bitcmp1_b32 s5, 1
    s_cselect_b32 s50, 4042752, 0
    s_xor_b32 s49, s49, s50
    s_bitcmp1_b32 s5, 2
    s_cselect_b32 s50, 2134016, 0
    s_xor_b32 s49, s49, s50
    s_bitcmp1_b32 s5, 3
    s_cselect_b32 s50, 3194880, 0
    s_xor_b32 s49, s49, s50
    v_mov_b32 v16, s49
    v_bfe_i32 v11, v0, 0, 1
    v_and_b32 v11, 32768, v11
    v_xor_b32 v16, v16, v11
    v_bfe_i32 v11, v0, 1, 1
    v_and_b32 v11, 45056, v11
    v_xor_b32 v16, v16, v11
    v_bfe_i32 v11, v0, 2, 1
    v_and_b32 v11, 1593344, v11
    v_xor_b32 v16, v16, v11
    v_bfe_i32 v11, v0, 3, 1
    v_and_b32 v11, 1855488, v11
    v_xor_b32 v16, v16, v11
    v_bfe_i32 v11, v0, 4, 1
    v_and_b32 v11, 1085440, v11
    v_xor_b32 v16, v16, v11
    v_bfe_i32 v11, v0, 5, 1
    v_and_b32 v11, 163840, v11
    v_xor_b32 v16, v16, v11
    v_mov_b32 v15, v16
    s_mov_b32 s8, s18
    s_mov_b32 s9, s19
    v_readlane_b32 s12, v15, 0
    s_mov_b32 s61, 1
    s_mov_b32 s10, 67108864
    s_mov_b32 s13, 1024
    v_mul_u32_u24 v11, 256, v6
    v_add_u32 v1, v11, v7
    v_add_u32 v2, v11, v10
    s_mov_b32 s15, 44
    s_call_b64 s[46:47], L_loopM
    s_lshr_b32 s50, s5, 3
    s_lshl_b32 s50, s50, 21
    s_and_b32 s49, s5, 7
    s_lshl_b32 s49, s49, 15
    s_add_u32 s49, s49, s50
    s_add_u32 s12, s49, s57
    v_mul_u32_u24 v15, 262144, v0
    v_add_u32 v15, s12, v15
    s_mov_b32 s8, s24
    s_mov_b32 s9, s25
    v_readlane_b32 s12, v15, 0
    s_mov_b32 s61, 1
    s_mov_b32 s10, 8388608
    s_mov_b32 s13, 8192
    v_mul_u32_u24 v11, 2048, v6
    v_add_u32 v1, v11, v7
    v_add_u32 v2, v11, v10
    s_mov_b32 s15, 48
    s_call_b64 s[46:47], L_loopM
L_ld_v:
    v_mov_b32 v15, v16
    s_mov_b32 s8, s20
    s_mov_b32 s9, s21
    v_readlane_b32 s12, v15, 0
    s_mov_b32 s61, 1
    s_mov_b32 s10, 67108864
    s_mov_b32 s13, 1024
    v_mul_u32_u24 v11, 256, v6
    v_add_u32 v1, v11, v7
    v_add_u32 v2, v11, v10
    s_add_u32 s15, s44, 32
    s_call_b64 s[46:47], L_loopM
    s_cmp_ge_u32 s2, 224
    s_cbranch_scc1 L_ld_drain
    s_mov_b32 s55, s5
    s_and_b32 s49, s55, 3
    s_mul_i32 s49, s49, 1835008
    s_lshr_b32 s50, s55, 2
    s_lshl3_add_u32 s50, s50, s4
    s_lshl_b32 s50, s50, 7
    s_add_u32 s54, s49, s50
    s_mov_b32 s12, s54
    v_mul_u32_u24 v15, 114688, v0
    v_add_u32 v15, s12, v15
    s_mov_b32 s8, s28
    s_mov_b32 s9, s29
    v_readlane_b32 s12, v15, 0
    s_mov_b32 s61, 1
    s_mov_b32 s10, 7340032
    s_mov_b32 s13, 28672
    v_mul_u32_u24 v11, 7168, v6
    v_and_b32 v12, 0x80, v7
    v_mul_u32_u24 v12, 7168, v12
    v_and_b32 v13, 0x70, v7
    v_add3_u32 v1, v11, v12, v13
    v_and_b32 v12, 0x80, v10
    v_mul_u32_u24 v12, 7168, v12
    v_and_b32 v13, 0x70, v10
    v_add3_u32 v2, v11, v12, v13
    s_mov_b32 s60, 1000
    s_waitcnt lgkmcnt(0)
    v_readfirstlane_b32 s50, v14
    s_mov_b32 s59, 83
    s_mov_b32 s58, 84
    s_cmp_eq_u32 s50, 2
    s_cselect_b32 s58, 84, s58
    s_cmp_eq_u32 s50, 1
    s_cselect_b32 s58, 84, s58
    s_sub_u32 s49, s44, 3
    s_max_i32 s53, s53, s49
    v_mov_b32 v11, s53
    s_waitcnt vmcnt(24)
    ds_write_b32 v5, v11 offset:0
    s_sub_u32 s49, s44, 2
    s_max_i32 s53, s53, s49
    v_mov_b32 v11, s53
    s_waitcnt vmcnt(16)
    ds_write_b32 v5, v11 offset:0
    s_sub_u32 s49, s44, 1
    s_max_i32 s53, s53, s49
    v_mov_b32 v11, s53
    s_waitcnt vmcnt(8)
    ds_write_b32 v5, v11 offset:0
    s_sub_u32 s49, s44, 0
    s_max_i32 s53, s53, s49
    v_mov_b32 v11, s53
    s_waitcnt vmcnt(0)
    ds_write_b32 v5, v11 offset:0
L_hold_1:
    ds_read_b32 v3, v4 offset:256
    s_sub_u32 s48, s48, 1
    s_cbranch_scc1 L_end
    s_waitcnt lgkmcnt(0)
    v_cmp_gt_i32 vcc, 80, v3
    s_cbranch_vccnz L_hold_1
L_noh1:
    s_mov_b32 s15, 84
    s_call_b64 s[46:47], L_loopT
    v_readlane_b32 s12, v15, 0
    s_mov_b32 s61, 1
    s_mov_b32 s8, s30
    s_mov_b32 s9, s31
    s_mov_b32 s15, 88
    s_call_b64 s[46:47], L_loopT
    s_lshl_b32 s49, s55, 18
    s_add_u32 s12, s49, s57
    v_mul_u32_u24 v15, 32768, v0
    v_add_u32 v15, s12, v15
    s_mov_b32 s8, s32
    s_mov_b32 s9, s33
    v_readlane_b32 s12, v15, 0
    s_mov_b32 s61, 1
    s_mov_b32 s10, 7340032
    s_mov_b32 s13, 8192
    v_mul_u32_u24 v11, 2048, v6
    v_add_u32 v1, v11, v7
    v_add_u32 v2, v11, v10
    s_mov_b32 s15, 92
    s_call_b64 s[46:47], L_loopT
L_ld_drain:
    s_sub_u32 s49, s44, 3
    s_max_i32 s53, s53, s49
    v_mov_b32 v11, s53
    s_waitcnt vmcnt(24)
    ds_write_b32 v5, v11 offset:0
    s_sub_u32 s49, s44, 2
    s_max_i32 s53, s53, s49
    v_mov_b32 v11, s53
    s_waitcnt vmcnt(16)
    ds_write_b32 v5, v11 offset:0
    s_sub_u32 s49, s44, 1
    s_max_i32 s53, s53, s49
    v_mov_b32 v11, s53
    s_waitcnt vmcnt(8)
    ds_write_b32 v5, v11 offset:0
    s_sub_u32 s49, s44, 0
    s_max_i32 s53, s53, s49
    v_mov_b32 v11, s53
    s_waitcnt vmcnt(0)
    ds_write_b32 v5, v11 offset:0
    s_endpgm
L_bodyM0:
    s_add_u32 m0, s45, 32768
    ds_read_b32 v3, v4 offset:256
    buffer_load_dwordx4 v1, s[8:11], s12 offen nt lds
    s_add_u32 m0, s45, 33792
    s_add_u32 s12, s12, s13
    buffer_load_dwordx4 v2, s[8:11], s12 offen nt lds
    v_readlane_b32 s14, v15, s61
    s_add_u32 s61, s61, 1
    s_waitcnt vmcnt(20)
    s_add_u32 m0, s45, 34816
    s_add_u32 s12, s12, s13
    buffer_load_dwordx4 v1, s[8:11], s12 offen nt lds
    s_add_u32 m0, s45, 35840
    s_add_u32 s12, s12, s13
    buffer_load_dwordx4 v2, s[8:11], s12 offen nt lds
    s_add_i32 s49, s44, -2
    s_max_i32 s53, s53, s49
    v_mov_b32 v11, s53
    s_waitcnt vmcnt(20)
    ds_write_b32 v5, v11 offset:0
    s_add_u32 m0, s45, 36864
    s_mov_b32 s12, s14
    buffer_load_dwordx4 v1, s[8:11], s12 offen nt lds
    s_add_u32 m0, s45, 37888
    s_add_u32 s12, s12, s13
    buffer_load_dwordx4 v2, s[8:11], s12 offen nt lds
    v_readlane_b32 s14, v15, s61
    s_add_u32 s61, s61, 1
    s_waitcnt vmcnt(20)
    s_add_u32 m0, s45, 38912
    s_add_u32 s12, s12, s13
    buffer_load_dwordx4 v1, s[8:11], s12 offen nt lds
    s_add_u32 m0, s45, 39936
    s_add_u32 s12, s12, s13
    buffer_load_dwordx4 v2, s[8:11], s12 offen nt lds
    ds_read_b32 v14, v4 offset:288
    s_waitcnt vmcnt(20)
    s_mov_b32 s12, s14
    s_add_u32 s44, s44, 1
    s_cmp_ge_u32 s44, s15
    s_cbranch_scc1 L_retM
L_loopM:
    s_waitcnt lgkmcnt(0)
    s_sub_i32 s49, s44, 16
    v_cmp_ge_i32 vcc, s49, v3
    s_and_b32 s45, s44, 15
    s_lshl_b32 s45, s45, 13
    s_cbranch_vccnz L_stallM
L_goM:
    v_readfirstlane_b32 s50, v14
    s_nop 0
    s_cmp_eq_u32 s50, 0
    s_cbranch_scc1 L_bodyM0
    s_cmp_eq_u32 s50, 2
    s_cbranch_scc1 L_bodyM2
L_bodyM1:
    s_add_u32 m0, s45, 32768
    ds_read_b32 v3, v4 offset:256
    buffer_load_dwordx4 v1, s[8:11], s12 offen nt lds
    s_add_u32 m0, s45, 33792
    s_add_u32 s12, s12, s13
    buffer_load_dwordx4 v2, s[8:11], s12 offen nt lds
    v_readlane_b32 s14, v15, s61
    s_add_u32 s61, s61, 1
    s_waitcnt vmcnt(12)
    s_add_u32 m0, s45, 34816
    s_add_u32 s12, s12, s13
    buffer_load_dwordx4 v1, s[8:11], s12 offen nt lds
    s_add_u32 m0, s45, 35840
    s_add_u32 s12, s12, s13
    buffer_load_dwordx4 v2, s[8:11], s12 offen nt lds
    s_add_i32 s49, s44, -1
    s_max_i32 s53, s53, s49
    v_mov_b32 v11, s53
    s_waitcnt vmcnt(12)
    ds_write_b32 v5, v11 offset:0
    s_add_u32 m0, s45, 36864
    s_mov_b32 s12, s14
    buffer_load_dwordx4 v1, s[8:11], s12 offen nt lds
    s_add_u32 m0, s45, 37888
    s_add_u32 s12, s12, s13
    buffer_load_dwordx4 v2, s[8:11], s12 offen nt lds
    v_readlane_b32 s14, v15, s61
    s_add_u32 s61, s61, 1
    s_waitcnt vmcnt(12)
    s_add_u32 m0, s45, 38912
    s_add_u32 s12, s12, s13
    buffer_load_dwordx4 v1, s[8:11], s12 offen nt lds
    s_add_u32 m0, s45, 39936
    s_add_u32 s12, s12, s13
    buffer_load_dwordx4 v2, s[8:11], s12 offen nt lds
    ds_read_b32 v14, v4 offset:288
    s_waitcnt vmcnt(12)
    s_mov_b32 s12, s14
    s_add_u32 s44, s44, 1
    s_cmp_lt_u32 s44, s15
    s_cbranch_scc1 L_loopM
L_retM:
    s_setpc_b64 s[46:47]
L_bodyM2:
    s_add_u32 m0, s45, 32768
    ds_read_b32 v3, v4 offset:256
    buffer_load_dwordx4 v1, s[8:11], s12 offen nt lds
    s_add_u32 m0, s45, 33792
    s_add_u32 s12, s12, s13
    buffer_load_dwordx4 v2, s[8:11], s12 offen nt lds
    v_readlane_b32 s14, v15, s61
    s_add_u32 s61, s61, 1
    s_waitcnt vmcnt(30)
    s_add_u32 m0, s45, 34816
    s_add_u32 s12, s12, s13
    buffer_load_dwordx4 v1, s[8:11], s12 offen nt lds
    s_add_u32 m0, s45, 35840
    s_add_u32 s12, s12, s13
    buffer_load_dwordx4 v2, s[8:11], s12 offen nt lds
    s_waitcnt vmcnt(30)
    s_add_u32 m0, s45, 36864
    s_mov_b32 s12, s14
    buffer_load_dwordx4 v1, s[8:11], s12 offen nt lds
    s_add_u32 m0, s45, 37888
    s_add_u32 s12, s12, s13
    buffer_load_dwordx4 v2, s[8:11], s12 offen nt lds
    v_readlane_b32 s14, v15, s61
    s_add_u32 s61, s61, 1
    s_add_i32 s49, s44, -3
    s_max_i32 s53, s53, s49
    v_mov_b32 v11, s53
    s_waitcnt vmcnt(30)
    ds_write_b32 v5, v11 offset:0
    s_add_u32 m0, s45, 38912
    s_add_u32 s12, s12, s13
    buffer_load_dwordx4 v1, s[8:11], s12 offen nt lds
    s_add_u32 m0, s45, 39936
    s_add_u32 s12, s12, s13
    buffer_load_dwordx4 v2, s[8:11], s12 offen nt lds
    ds_read_b32 v14, v4 offset:288
    s_waitcnt vmcnt(30)
    s_mov_b32 s12, s14
    s_add_u32 s44, s44, 1
    s_cmp_lt_u32 s44, s15
    s_cbranch_scc1 L_loopM
    s_setpc_b64 s[46:47]
L_stallM:
    ds_read_b32 v3, v4 offset:256
    s_sub_u32 s48, s48, 1
    s_cbranch_scc1 L_end
    s_waitcnt lgkmcnt(0)
    v_cmp_ge_i32 vcc, s49, v3
    s_cbranch_vccnz L_stallM
    s_branch L_goM
L_loopT:
    s_cmp_eq_u32 s44, s58
    s_cbranch_scc1 L_holdT
    s_waitcnt lgkmcnt(0)
    s_sub_i32 s49, s44, 16
    v_cmp_ge_i32 vcc, s49, v3
    s_and_b32 s45, s44, 15
    s_lshl_b32 s45, s45, 13
    s_cbranch_vccnz L_stallT
L_goT:
L_bodyT0:
    s_add_u32 m0, s45, 32768
    ds_read_b32 v3, v4 offset:256
    buffer_load_dwordx4 v1, s[8:11], s12 offen nt lds
    s_add_u32 m0, s45, 33792
    s_add_u32 s12, s12, s13
    buffer_load_dwordx4 v2, s[8:11], s12 offen nt lds
    v_readlane_b32 s14, v15, s61
    s_add_u32 s61, s61, 1
    s_waitcnt vmcnt(30)
    s_add_u32 m0, s45, 34816
    s_add_u32 s12, s12, s13
    buffer_load_dwordx4 v1, s[8:11], s12 offen nt lds
    s_add_u32 m0, s45, 35840
    s_add_u32 s12, s12, s13
    buffer_load_dwordx4 v2, s[8:11], s12 offen nt lds
    s_waitcnt vmcnt(30)
    s_add_u32 m0, s45, 36864
    s_mov_b32 s12, s14
    buffer_load_dwordx4 v1, s[8:11], s12 offen nt lds
    s_add_u32 m0, s45, 37888
    s_add_u32 s12, s12, s13
    buffer_load_dwordx4 v2, s[8:11], s12 offen nt lds
    v_readlane_b32 s14, v15, s61
    s_add_u32 s61, s61, 1
    s_add_i32 s49, s44, -3
    s_max_i32 s53, s53, s49
    v_mov_b32 v11, s53
    s_waitcnt vmcnt(30)
    ds_write_b32 v5, v11 offset:0
    s_add_u32 m0, s45, 38912
    s_add_u32 s12, s12, s13
    buffer_load_dwordx4 v1, s[8:11], s12 offen nt lds
    s_add_u32 m0, s45, 39936
    s_add_u32 s12, s12, s13
    buffer_load_dwordx4 v2, s[8:11], s12 offen nt lds
    s_waitcnt vmcnt(30)
    s_mov_b32 s12, s14
    s_add_u32 s44, s44, 1
    s_cmp_lt_u32 s44, s15
    s_cbranch_scc1 L_loopT
    s_setpc_b64 s[46:47]
L_stallT:
    ds_read_b32 v3, v4 offset:256
    s_sub_u32 s48, s48, 1
    s_cbranch_scc1 L_end
    s_waitcnt lgkmcnt(0)
    v_cmp_ge_i32 vcc, s49, v3
    s_cbranch_vccnz L_stallT
    s_branch L_goT
L_holdT:
    v_mov_b32 v11, s59
    v_mov_b32 v12, 0
    ds_write_b32 v12, v11 offset:300
    s_sub_u32 s49, s44, 3
    s_max_i32 s53, s53, s49
    v_mov_b32 v11, s53
    s_waitcnt vmcnt(24)
    ds_write_b32 v5, v11 offset:0
    s_sub_u32 s49, s44, 2
    s_max_i32 s53, s53, s49
    v_mov_b32 v11, s53
    s_waitcnt vmcnt(16)
    ds_write_b32 v5, v11 offset:0
    s_sub_u32 s49, s44, 1
    s_max_i32 s53, s53, s49
    v_mov_b32 v11, s53
    s_waitcnt vmcnt(8)
    ds_write_b32 v5, v11 offset:0
    s_sub_u32 s49, s44, 0
    s_max_i32 s53, s53, s49
    v_mov_b32 v11, s53
    s_waitcnt vmcnt(0)
    ds_write_b32 v5, v11 offset:0
L_hold_2:
    ds_read_b32 v3, v4 offset:256
    s_sub_u32 s48, s48, 1
    s_cbranch_scc1 L_end
    s_waitcnt lgkmcnt(0)
    v_cmp_gt_i32 vcc, s59, v3
    s_cbranch_vccnz L_hold_2
    s_cmp_eq_u32 s59, 84
    s_cselect_b32 s58, 90, 0
    s_cmp_eq_u32 s59, 83
    s_cselect_b32 s58, 88, s58
    s_add_u32 s59, s59, 1
    s_branch L_loopT
L_notloader:
    v_and_b32 v0, 63, v0
    s_mov_b32 s48, 1048576
    s_lshl_b32 s49, s4, 18
    s_add_u32 s49, s49, 524288
    s_mov_b32 s10, 499712
    s_mov_b32 s11, 0x20000
    s_mov_b32 s14, 262144
    s_mov_b32 s15, 0x20000
    s_waitcnt lgkmcnt(0)
    s_load_dword s6, s[42:43], 393216
    s_barrier
    s_mov_b32 s8, s42
    s_mov_b32 s9, s43
    s_add_u32 s12, s42, s49
    s_addc_u32 s13, s43, 0
    s_cmp_lg_u32 s3, 9
    s_cbranch_scc1 L_consumer
    s_mul_i32 s51, s5, 6400
    v_min_u32 v8, 49, v0
    v_lshlrev_b32 v8, 7, v8
    buffer_load_dword v11, v8, s[12:15], s51 offen sc1 nt
    buffer_load_dword v11, v8, s[12:15], s51 offen sc1
    s_getreg_b32 s50, hwreg(HW_REG_XCC_ID, 0, 8)
    s_lshl_b32 s50, s50, 16
    v_and_b32 v2, 31, v0
    v_lshlrev_b32 v2, 4, v2
    s_lshl_b32 s51, s5, 4
    v_mov_b32 v3, s51
    s_mov_b32 s52, 198656
    s_add_u32 s60, s42, 393216
    s_addc_u32 s61, s43, 0
    v_mov_b32 v1, 0
    s_waitcnt lgkmcnt(0)
    s_add_u32 s6, s6, 13605
    s_and_b32 s6, s6, 0xffff
    s_or_b32 s50, s50, s6
    v_mov_b32 v4, s50
    v_add_u32 v5, 19219, v4
    v_add_u32 v6, 19219, v5
    v_add_u32 v7, 19219, v6
    s_mov_b64 exec, 1
    buffer_store_dwordx4 v[4:7], v3, s[12:15], s52 offen
    s_mov_b64 exec, -1
    s_mov_b32 s54, 24
L_hello:
    buffer_load_dwordx4 v[12:15], v2, s[12:15], s52 offen sc1 nt
    s_sub_u32 s54, s54, 1
    s_cbranch_scc1 L_hello2
    s_waitcnt vmcnt(0)
    v_xor_b32 v12, v12, v4
    v_xor_b32 v13, v13, v5
    v_xor_b32 v14, v14, v6
    v_xor_b32 v15, v15, v7
    v_or_b32 v12, v12, v13
    v_or3_b32 v12, v12, v14, v15
    v_cmp_ne_u32 vcc, 0, v12
    s_cbranch_vccnz L_hello
    v_mov_b32 v2, 1
    ds_write_b32 v1, v2 offset:292
    s_branch L_board
L_hello2:
    ds_write_b32 v1, v1 offset:288
    s_endpgm
L_board:
    s_lshl_b32 s54, s6, 16
    v_min_u32 v2, 32, v0
    v_lshlrev_b32 v2, 2, v2
    s_mov_b32 s55, 199680
    s_lshl2_add_u32 s56, s5, s55
    s_cmp_ge_u32 s2, 224
    s_cselect_b32 s57, 1, 0
    s_lshl_b32 s58, s4, 8
    s_add_u32 s58, s58, 393216
    s_mov_b32 s45, 384
    s_mov_b32 s59, 0
L_bd1:
    ds_read_b32 v3, v1 offset:0
    s_sub_u32 s48, s48, 1
    s_cbranch_scc1 L_end
    s_waitcnt lgkmcnt(0)
    v_readfirstlane_b32 s49, v3
    s_nop 0
    s_cmp_ge_i32 s49, 78
    s_cselect_b32 s44, 1, 0
    s_sub_i32 s49, s49, s57
    s_max_i32 s49, s49, 0
    s_or_b32 s50, s49, s54
    v_mov_b32 v3, s50
    s_mov_b64 exec, 1
    buffer_store_dword v3, v1, s[12:15], s56 offen
    s_mov_b64 exec, -1
    s_cmp_eq_u32 s44, 1
    s_cbranch_scc1 L_end
    buffer_load_dword v4, v2, s[12:15], s55 offen sc1
    v_mov_b32 v6, s49
    s_waitcnt vmcnt(0)
    v_xor_b32 v4, s54, v4
    v_cmp_gt_u32 vcc, 0x10000, v4
    v_readlane_b32 s51, v4, 32
    s_nop 0
    v_cndmask_b32 v5, v6, v4, vcc
    s_nop 1
    v_add_u32_dpp v5, v5, v5 row_ror:8 row_mask:0xf bank_mask:0xf
    s_nop 1
    v_add_u32_dpp v5, v5, v5 row_ror:4 row_mask:0xf bank_mask:0xf
    s_nop 1
    v_add_u32_dpp v5, v5, v5 row_ror:2 row_mask:0xf bank_mask:0xf
    s_nop 1
    v_add_u32_dpp v5, v5, v5 row_ror:1 row_mask:0xf bank_mask:0xf
    s_nop 0
    v_readlane_b32 s50, v5, 0
    v_readlane_b32 s52, v5, 16
    s_cmp_lt_u32 s51, 0x10000
    s_cselect_b32 s51, s51, 0x8000
    s_add_u32 s50, s50, s52
    s_lshl_b32 s49, s49, 5
    s_sub_i32 s49, s50, s49
    s_add_i32 s49, s49, s51
    s_mov_b32 s52, 0
    s_cmp_lt_i32 s49, 32656
    s_cselect_b32 s52, 1, s52
    s_cmp_ge_i32 s49, 32768
    s_cselect_b32 s52, 2, s52
    v_mov_b32 v3, s52
    ds_write_b32 v1, v3 offset:288
    s_branch L_bd1
L_consumer:
    s_sub_u32 s3, s3, 1
    v_lshlrev_b32 v1, 2, v0
    s_lshr_b32 s49, s3, 1
    s_lshl_b32 s49, s49, 11
    s_and_b32 s50, s3, 1
    s_lshl_b32 s50, s50, 8
    s_add_u32 s49, s49, s50
    s_and_b32 s50, s5, 3
    s_lshl_b32 s50, s50, 9
    s_add_u32 s49, s49, s50
    v_add_u32 v12, s49, v1
    global_load_dword v20, v12, s[34:35]
    s_mov_b32 s53, 0
    s_movk_i32 s7, 0xff
    s_movk_i32 s45, 0xff00
    s_mov_b32 s36, 0xffff
    v_mov_b32 v147, 0
    v_and_b32 v5, 28, v1
    s_lshl_b32 s49, s3, 2
    v_mov_b32 v6, s49
    v_lshlrev_b32 v150, 4, v0
    v_lshrrev_b32 v152, 4, v0
    v_and_b32 v153, 3, v0
    v_bfe_u32 v154, v0, 2, 2
    v_lshl_add_u32 v155, v153, 2, v152
    v_lshlrev_b32 v156, 6, v154
    v_lshl_add_u32 v156, v155, 2, v156
    s_cmp_lg_u32 s5, 24
    s_cbranch_scc1 L_nox
    s_lshl_b32 s49, s3, 10
    v_add_u32 v10, s49, v150
    s_lshl3_add_u32 s49, s4, s3
    s_lshl_b32 s49, s49, 5
    v_lshlrev_b32 v11, 11, v154
    v_lshl_add_u32 v11, v155, 1, v11
    v_add_u32 v11, s49, v11
    global_load_dwordx4 v[16:19], v10, s[16:17]
    global_load_ushort v132, v11, s[16:17]
    s_lshl_b32 s49, s49, 5
    s_add_u32 s49, s49, 425984
    v_mov_b32 v24, -1
    v_mov_b32 v25, -1
    v_mov_b32 v26, -1
    v_mov_b32 v27, -1
    buffer_store_dwordx4 v[24:27], v150, s[8:11], s49 offen sc1
    s_lshl3_add_u32 s49, s4, s3
    s_lshl_b32 s49, s49, 7
    s_add_u32 s49, s49, 491520
    s_mov_b64 exec, 0xff
    buffer_store_dwordx4 v[24:27], v150, s[8:11], s49 offen sc1
    s_mov_b64 exec, -1
L_nox:
    v_lshrrev_b32 v8, 2, v0
    v_and_b32 v9, 7, v8
    v_lshlrev_b32 v9, 1, v9
    v_bfe_u32 v10, v0, 1, 1
    s_lshl_b32 s49, s3, 1
    v_or_b32 v10, s49, v10
    v_xor_b32 v10, v10, v9
    v_lshlrev_b32 v2, 8, v8
    v_lshl_add_u32 v2, v10, 4, v2
    v_and_b32 v10, 1, v0
    v_lshl_add_u32 v2, v10, 3, v2
    v_lshlrev_b32 v3, 6, v152
    v_lshl_add_u32 v3, v153, 4, v3
    v_lshlrev_b32 v4, 4, v152
    v_lshl_add_u32 v4, v153, 6, v4
    v_lshl_or_b32 v4, v154, 29, v4
    v_and_b32 v10, 7, v0
    v_lshlrev_b32 v7, 7, v152
    v_lshl_add_u32 v7, v10, 4, v7
    v_lshlrev_b32 v10, 1, v10
    v_xor_b32 v10, v10, v152
    v_and_b32 v9, 15, v0
    v_lshlrev_b32 v151, 8, v9
    v_lshl_add_u32 v151, v10, 4, v151
    s_lshl_b32 s49, s3, 4
    v_add_u32 v10, s49, v155
    v_lshrrev_b32 v148, 5, v10
    v_lshlrev_b32 v148, 8, v148
    v_bfe_u32 v14, v10, 2, 2
    v_lshl_add_u32 v148, v14, 6, v148
    v_lshl_add_u32 v148, v154, 4, v148
    v_bfe_u32 v14, v10, 4, 1
    v_lshl_add_u32 v148, v14, 3, v148
    v_and_b32 v14, 3, v10
    v_lshl_add_u32 v148, v14, 1, v148
    s_waitcnt lgkmcnt(0)
    s_add_u32 s6, s6, 13605
    v_mov_b32 v8, 19219
    v_mad_u32_u24 v145, v152, v8, s6
    v_mad_u32_u24 v146, v153, v8, s6
    s_cmp_ge_u32 s2, 192
    s_cbranch_scc1 L_noA
    s_and_b32 s49, s3, 1
    s_lshl_b32 s49, s49, 7
    v_lshl_add_u32 v8, v0, 1, s49
    s_lshr_b32 s49, s3, 1
    v_mov_b32 v9, s49
    v_lshrrev_b32 v10, 5, v8
    v_lshlrev_b32 v10, 8, v10
    v_bfe_u32 v14, v8, 2, 2
    v_lshl_add_u32 v10, v14, 6, v10
    v_lshl_add_u32 v10, v9, 4, v10
    v_bfe_u32 v14, v8, 4, 1
    v_lshl_add_u32 v10, v14, 3, v10
    v_and_b32 v14, 3, v8
    v_lshl_add_u32 v10, v14, 1, v10
    s_waitcnt vmcnt(0)
    v_lshlrev_b32 v8, 16, v20
    v_and_b32 v9, 0xffff0000, v20
    v_mul_f32 v11, 0xbfb8aa3b, v8
    v_mul_f32 v12, 0xbfb8aa3b, v9
    v_exp_f32 v11, v11
    v_exp_f32 v12, v12
    v_add_f32 v11, 1.0, v11
    v_add_f32 v12, 1.0, v12
    v_rcp_f32 v11, v11
    v_rcp_f32 v12, v12
    v_mul_f32 v8, v8, v11
    v_mul_f32 v9, v9, v12
    v_cvt_pk_bf16_f32 v8, v8, v9
    ds_write_b32 v10, v8 offset:8192
    v_mov_b32 v15, 1
    ds_write_b32 v6, v15 offset:320
L_cs_3:
    ds_read_b32 v15, v5 offset:320
    s_sub_u32 s48, s48, 1
    s_cbranch_scc1 L_end
    s_waitcnt lgkmcnt(0)
    v_cmp_gt_u32 vcc, 1, v15
    s_cbranch_vccnz L_cs_3
    ds_read_b128 v[48:51], v3 offset:8192
    ds_read_b128 v[52:55], v3 offset:8448
    ds_read_b128 v[56:59], v3 offset:8704
    ds_read_b128 v[60:63], v3 offset:8960
    ds_read_b128 v[64:67], v3 offset:9216
    ds_read_b128 v[68:71], v3 offset:9472
    ds_read_b128 v[72:75], v3 offset:9728
    ds_read_b128 v[76:79], v3 offset:9984
    s_waitcnt lgkmcnt(0)
    v_add_u32 v8, 32768, v2
    s_lshr_b32 s50, s5, 2
    s_lshl3_add_u32 s50, s50, s3
    s_and_b32 s51, s5, 3
    s_lshl2_add_u32 s50, s50, s51
    s_lshl_b32 s50, s50, 8
    s_add_u32 s50, s50, 131072
    s_cmp_ge_i32 s53, 4
    s_cbranch_scc1 L_wd_5
L_wl_4:
    ds_read_b32 v15, v1 offset:0
    s_sub_u32 s48, s48, 1
    s_cbranch_scc1 L_end
    s_waitcnt lgkmcnt(0)
    v_readfirstlane_b32 s53, v15
    s_nop 0
    s_cmp_lt_i32 s53, 4
    s_cbranch_scc1 L_wl_4
L_wd_5:
    ds_read_b64_tr_b16 v[16:17], v8 offset:0
    ds_read_b64_tr_b16 v[18:19], v8 offset:4096
    ds_read_b64_tr_b16 v[20:21], v8 offset:8192
    ds_read_b64_tr_b16 v[22:23], v8 offset:12288
    ds_read_b64_tr_b16 v[24:25], v8 offset:16384
    ds_read_b64_tr_b16 v[26:27], v8 offset:20480
    ds_read_b64_tr_b16 v[28:29], v8 offset:24576
    ds_read_b64_tr_b16 v[30:31], v8 offset:28672
    s_waitcnt lgkmcnt(0)
    v_mov_b32 v15, 4
    ds_write_b32 v6, v15 offset:256
    v_mfma_f32_16x16x32_bf16 v[136:139], v[16:19], v[48:51], 0
    v_mfma_f32_16x16x32_bf16 v[136:139], v[20:23], v[52:55], v[136:139]
    v_mfma_f32_16x16x32_bf16 v[136:139], v[24:27], v[56:59], v[136:139]
    v_mfma_f32_16x16x32_bf16 v[136:139], v[28:31], v[60:63], v[136:139]
    s_cmp_ge_i32 s53, 8
    s_cbranch_scc1 L_wd_7
L_wl_6:
    ds_read_b32 v15, v1 offset:0
    s_sub_u32 s48, s48, 1
    s_cbranch_scc1 L_end
    s_waitcnt lgkmcnt(0)
    v_readfirstlane_b32 s53, v15
    s_nop 0
    s_cmp_lt_i32 s53, 8
    s_cbranch_scc1 L_wl_6
L_wd_7:
    ds_read_b64_tr_b16 v[32:33], v8 offset:32768
    ds_read_b64_tr_b16 v[34:35], v8 offset:36864
    ds_read_b64_tr_b16 v[36:37], v8 offset:40960
    ds_read_b64_tr_b16 v[38:39], v8 offset:45056
    ds_read_b64_tr_b16 v[40:41], v8 offset:49152
    ds_read_b64_tr_b16 v[42:43], v8 offset:53248
    ds_read_b64_tr_b16 v[44:45], v8 offset:57344
    ds_read_b64_tr_b16 v[46:47], v8 offset:61440
    ds_read_b32 v15, v147 offset:292
    s_waitcnt lgkmcnt(0)
    v_readfirstlane_b32 s37, v15
    v_mov_b32 v15, 8
    ds_write_b32 v6, v15 offset:256
    v_mfma_f32_16x16x32_bf16 v[136:139], v[32:35], v[64:67], v[136:139]
    v_mfma_f32_16x16x32_bf16 v[136:139], v[36:39], v[68:71], v[136:139]
    v_mfma_f32_16x16x32_bf16 v[136:139], v[40:43], v[72:75], v[136:139]
    v_mfma_f32_16x16x32_bf16 v[136:139], v[44:47], v[76:79], v[136:139]
    s_cmp_eq_u32 s37, 0
    s_nop 6
    v_bfi_b32 v136, s7, v145, v136
    v_bfi_b32 v137, s7, v145, v137
    s_cbranch_scc1 L_sg_8
    buffer_store_dwordx4 v[136:139], v4, s[12:15], s50 offen
L_sd_9:
L_noA:
    v_add_u32 v8, 98304, v2
    s_cmp_ge_i32 s53, 12
    s_cbranch_scc1 L_wd_11
L_wl_10:
    ds_read_b32 v15, v1 offset:0
    s_sub_u32 s48, s48, 1
    s_cbranch_scc1 L_end
    s_waitcnt lgkmcnt(0)
    v_readfirstlane_b32 s53, v15
    s_nop 0
    s_cmp_lt_i32 s53, 12
    s_cbranch_scc1 L_wl_10
L_wd_11:
    ds_read_b64_tr_b16 v[112:113], v8 offset:0
    ds_read_b64_tr_b16 v[114:115], v8 offset:4096
    ds_read_b64_tr_b16 v[116:117], v8 offset:8192
    ds_read_b64_tr_b16 v[118:119], v8 offset:12288
    ds_read_b64_tr_b16 v[120:121], v8 offset:16384
    ds_read_b64_tr_b16 v[122:123], v8 offset:20480
    ds_read_b64_tr_b16 v[124:125], v8 offset:24576
    ds_read_b64_tr_b16 v[126:127], v8 offset:28672
    s_add_u32 s54, s3, 12
    s_waitcnt lgkmcnt(0)
    v_mov_b32 v15, s54
    ds_write_b32 v6, v15 offset:256
    s_lshl_b32 s50, s3, 10
    s_lshl3_add_u32 s52, s4, s3
    s_cmp_eq_u32 s5, 25
    s_cbranch_scc1 L_us
    s_cmp_ge_u32 s5, 28
    s_cbranch_scc1 L_gab
    s_cmp_lg_u32 s5, 24
    s_cbranch_scc1 L_nored
    s_waitcnt vmcnt(0)
    v_lshlrev_b32 v12, 16, v16
    v_and_b32 v13, 0xffff0000, v16
    v_add_f32 v8, v12, v13
    v_mul_f32 v9, v12, v12
    v_fmac_f32 v9, v13, v13
    v_lshlrev_b32 v12, 16, v17
    v_and_b32 v13, 0xffff0000, v17
    v_add_f32 v8, v8, v12
    v_fmac_f32 v9, v12, v12
    v_add_f32 v8, v8, v13
    v_fmac_f32 v9, v13, v13
    v_lshlrev_b32 v12, 16, v18
    v_and_b32 v13, 0xffff0000, v18
    v_add_f32 v8, v8, v12
    v_fmac_f32 v9, v12, v12
    v_add_f32 v8, v8, v13
    v_fmac_f32 v9, v13, v13
    v_lshlrev_b32 v12, 16, v19
    v_and_b32 v13, 0xffff0000, v19
    v_add_f32 v8, v8, v12
    v_fmac_f32 v9, v12, v12
    v_add_f32 v8, v8, v13
    v_fmac_f32 v9, v13, v13
    s_nop 1
    v_permlane32_swap_b32 v8, v9
    v_add_f32 v8, v8, v9
    v_mov_b32 v9, v8
    s_nop 1
    v_permlane16_swap_b32 v8, v9
    v_add_f32 v8, v8, v9
    s_nop 1
    v_add_f32_dpp v8, v8, v8 row_ror:8 row_mask:0xf bank_mask:0xf
    s_nop 1
    v_add_f32_dpp v8, v8, v8 row_ror:4 row_mask:0xf bank_mask:0xf
    s_nop 1
    v_add_f32_dpp v8, v8, v8 row_ror:2 row_mask:0xf bank_mask:0xf
    s_nop 1
    v_add_f32_dpp v8, v8, v8 row_ror:1 row_mask:0xf bank_mask:0xf
    v_lshrrev_b32 v9, 5, v0
    v_lshlrev_b32 v9, 2, v9
    v_lshl_add_u32 v9, v6, 1, v9
    ds_write_b32 v9, v8 offset:384
    v_lshlrev_b32 v8, 4, v154
    v_mov_b32 v15, 1
    ds_write_b32 v6, v15 offset:320
L_cs_12:
    ds_read_b32 v15, v5 offset:320
    s_sub_u32 s48, s48, 1
    s_cbranch_scc1 L_end
    s_waitcnt lgkmcnt(0)
    v_cmp_gt_u32 vcc, 1, v15
    s_cbranch_vccnz L_cs_12
    ds_read_b128 v[128:131], v8 offset:384
    s_waitcnt lgkmcnt(0)
    v_add_f32 v8, v128, v130
    v_add_f32 v9, v129, v131
    v_mul_f32 v8, 0x3a800000, v8
    v_mul_f32 v9, 0x3a800000, v9
    v_fma_f32 v9, -v8, v8, v9
    v_max_f32 v9, 0, v9
    v_cvt_pk_bf16_f32 v9, v9, v9
    v_lshlrev_b32 v9, 16, v9
    v_cvt_pk_bf16_f32 v8, v8, v8
    v_lshlrev_b32 v8, 16, v8
    v_add_f32 v9, 0x3727c5ac, v9
    v_cvt_pk_bf16_f32 v9, v9, v9
    v_lshlrev_b32 v9, 16, v9
    v_sqrt_f32 v9, v9
    s_nop 0
    v_cvt_pk_bf16_f32 v9, v9, v9
    v_lshlrev_b32 v9, 16, v9
    v_rcp_f32 v9, v9
    v_lshlrev_b32 v132, 16, v132
    v_sub_f32 v132, v132, v8
    v_cvt_pk_bf16_f32 v132, v132, v132
    v_lshlrev_b32 v132, 16, v132
    v_mul_f32 v132, v132, v9
    v_cvt_pk_bf16_f32 v132, v132, v132
    v_lshlrev_b32 v132, 16, v132
    s_add_u32 s50, s50, 131072
    s_add_u32 s51, s50, 8192
    s_lshl_b32 s52, s52, 8
    s_add_u32 s52, s52, 114688
    buffer_load_dwordx4 v[16:19], v150, s[12:15], s50 offen offset:0 sc1
    buffer_load_dwordx4 v[20:23], v150, s[12:15], s51 offen offset:0 sc1
L_g_13:
    s_waitcnt vmcnt(0)
    v_bitop3_b32 v14, v16, v17, v146 bitop3:0x7e
    v_cmp_ne_u32_sdwa s[20:21], v14, v147 src0_sel:BYTE_0 src1_sel:DWORD
    v_bitop3_b32 v15, v20, v21, v146 bitop3:0x7e
    v_cmp_ne_u32_sdwa s[22:23], v15, v147 src0_sel:BYTE_0 src1_sel:DWORD
    s_nop 0
    s_or_b64 vcc, s[20:21], s[22:23]
    s_cbranch_scc1 L_gr_15
    v_and_b32 v16, s45, v16
    v_and_b32 v17, s45, v17
    v_and_b32 v20, s45, v20
    v_and_b32 v21, s45, v21
    v_permlane32_swap_b32 v16, v18
    v_permlane32_swap_b32 v17, v19
    v_permlane32_swap_b32 v20, v22
    v_permlane32_swap_b32 v21, v23
    v_add_f32 v16, v16, v18
    v_add_f32 v17, v17, v19
    v_add_f32 v20, v20, v22
    v_add_f32 v21, v21, v23
    v_permlane16_swap_b32 v16, v17
    s_nop 0
    v_permlane16_swap_b32 v20, v21
    v_add_f32 v16, v16, v17
    v_add_f32 v20, v20, v21
    v_cvt_pk_bf16_f32 v16, v16, v16
    v_lshlrev_b32 v16, 16, v16
    v_cvt_pk_bf16_f32 v20, v20, v20
    v_lshlrev_b32 v20, 16, v20
    v_add_f32 v20, 1.0, v20
    v_cvt_pk_bf16_f32 v20, v20, v20
    v_lshlrev_b32 v20, 16, v20
    v_mul_f32 v20, v132, v20
    v_cvt_pk_bf16_f32 v20, v20, v20
    v_lshlrev_b32 v20, 16, v20
    v_add_f32 v16, v16, v20
    v_cvt_pk_bf16_f32 v16, v16, v16
    v_bfi_b32 v16, s36, v146, v16
    buffer_store_dword v16, v156, s[8:11], s52 offen sc1
    s_branch L_nored
L_us:
    s_add_u32 s50, s50, 155648
    s_add_u32 s51, s50, 8192
    s_lshl_b32 s52, s52, 9
    s_add_u32 s52, s52, 131072
    v_lshlrev_b32 v8, 3, v0
    buffer_load_dwordx4 v[16:19], v150, s[12:15], s50 offen offset:0 sc1
    buffer_load_dwordx4 v[20:23], v150, s[12:15], s51 offen offset:0 sc1
L_g_18:
    s_waitcnt vmcnt(0)
    v_bitop3_b32 v14, v16, v17, v146 bitop3:0x7e
    v_cmp_ne_u32_sdwa s[20:21], v14, v147 src0_sel:BYTE_0 src1_sel:DWORD
    v_bitop3_b32 v15, v20, v21, v146 bitop3:0x7e
    v_cmp_ne_u32_sdwa s[22:23], v15, v147 src0_sel:BYTE_0 src1_sel:DWORD
    s_nop 0
    s_or_b64 vcc, s[20:21], s[22:23]
    s_cbranch_scc1 L_gr_20
    v_and_b32 v16, s45, v16
    v_and_b32 v17, s45, v17
    v_and_b32 v20, s45, v20
    v_and_b32 v21, s45, v21
    v_permlane32_swap_b32 v16, v18
    v_permlane32_swap_b32 v17, v19
    v_permlane32_swap_b32 v20, v22
    v_permlane32_swap_b32 v21, v23
    v_add_f32 v16, v16, v18
    v_add_f32 v17, v17, v19
    v_add_f32 v20, v20, v22
    v_add_f32 v21, v21, v23
    v_permlane16_swap_b32 v16, v17
    s_nop 0
    v_permlane16_swap_b32 v20, v21
    v_add_f32 v16, v16, v17
    v_add_f32 v20, v20, v21
    v_cvt_pk_bf16_f32 v20, v20, v20
    v_lshlrev_b32 v20, 16, v20
    v_add_f32 v17, 1.0, v20
    v_cvt_pk_bf16_f32 v16, v16, v16
    v_cvt_pk_bf16_f32 v17, v17, v17
    v_bfi_b32 v16, s36, v146, v16
    buffer_store_dwordx2 v[16:17], v8, s[8:11], s52 offen sc1
    s_branch L_nored
L_gab:
    s_and_b32 s49, s5, 3
    s_lshr_b32 s50, s3, 2
    s_lshl1_add_u32 s50, s49, s50
    s_lshl_b32 s50, s50, 10
    s_and_b32 s51, s3, 3
    s_lshl_b32 s51, s51, 6
    s_add_u32 s50, s50, s51
    s_add_u32 s51, s50, 147456
    s_add_u32 s52, s50, 172032
    v_lshlrev_b32 v9, 8, v152
    v_lshl_add_u32 v9, v153, 4, v9
    buffer_load_dwordx4 v[16:19], v9, s[12:15], s51 offen offset:0 sc1
    buffer_load_dwordx4 v[20:23], v9, s[12:15], s52 offen offset:0 sc1
L_g_23:
    s_waitcnt vmcnt(0)
    v_bitop3_b32 v14, v16, v17, v146 bitop3:0x7e
    v_cmp_ne_u32_sdwa s[20:21], v14, v147 src0_sel:BYTE_0 src1_sel:DWORD
    v_bitop3_b32 v15, v20, v21, v146 bitop3:0x7e
    v_cmp_ne_u32_sdwa s[22:23], v15, v147 src0_sel:BYTE_0 src1_sel:DWORD
    s_nop 0
    s_or_b64 vcc, s[20:21], s[22:23]
    s_cbranch_scc1 L_gr_25
    v_and_b32 v16, s45, v16
    v_and_b32 v17, s45, v17
    v_and_b32 v20, s45, v20
    v_and_b32 v21, s45, v21
    v_permlane32_swap_b32 v16, v18
    v_permlane32_swap_b32 v17, v19
    v_permlane32_swap_b32 v20, v22
    v_permlane32_swap_b32 v21, v23
    v_add_f32 v16, v16, v18
    v_add_f32 v17, v17, v19
    v_add_f32 v20, v20, v22
    v_add_f32 v21, v21, v23
    v_permlane16_swap_b32 v16, v17
    s_nop 0
    v_permlane16_swap_b32 v20, v21
    v_add_f32 v16, v16, v17
    v_add_f32 v20, v20, v21
    v_cvt_pk_bf16_f32 v143, v16, v20
    v_lshlrev_b32 v141, 16, v143
    v_and_b32 v143, 0xffff0000, v143
L_nored:
    s_add_u32 s49, s54, 1
    s_cmp_ge_i32 s53, s49
    s_cbranch_scc1 L_wd_29
L_wl_28:
    ds_read_b32 v15, v1 offset:0
    s_sub_u32 s48, s48, 1
    s_cbranch_scc1 L_end
    s_waitcnt lgkmcnt(0)
    v_readfirstlane_b32 s53, v15
    s_nop 0
    s_cmp_lt_i32 s53, s49
    s_cbranch_scc1 L_wl_28
L_wd_29:
    s_and_b32 s49, s54, 15
    s_lshl_b32 s49, s49, 13
    s_add_u32 s49, s49, 32768
    v_add_u32 v8, s49, v151
    v_xor_b32 v9, 64, v8
    v_xor_b32 v10, 0x80, v8
    v_xor_b32 v11, 0xc0, v8
    ds_read_b128 v[16:19], v8 offset:0
    ds_read_b128 v[20:23], v9 offset:0
    ds_read_b128 v[24:27], v10 offset:0
    ds_read_b128 v[28:31], v11 offset:0
    ds_read_b128 v[32:35], v8 offset:4096
    ds_read_b128 v[36:39], v9 offset:4096
    ds_read_b128 v[40:43], v10 offset:4096
    ds_read_b128 v[44:47], v11 offset:4096
    s_add_u32 s54, s54, 8
    s_waitcnt lgkmcnt(0)
    v_mov_b32 v15, s54
    ds_write_b32 v6, v15 offset:256
    s_cmp_lt_u32 s2, 192
    s_cselect_b32 s49, 21, 23
    s_cmp_ge_i32 s53, s49
    s_cbranch_scc1 L_wd_31
L_wl_30:
    ds_read_b32 v15, v1 offset:0
    s_sub_u32 s48, s48, 1
    s_cbranch_scc1 L_end
    s_waitcnt lgkmcnt(0)
    v_readfirstlane_b32 s53, v15
    s_nop 0
    s_cmp_lt_i32 s53, s49
    s_cbranch_scc1 L_wl_30
L_wd_31:
    ds_read_b32 v15, v147 offset:292
    s_waitcnt lgkmcnt(0)
    v_readfirstlane_b32 s37, v15
    s_and_b32 s49, s5, 7
    s_lshl3_add_u32 s50, s49, s3
    s_lshl_b32 s50, s50, 8
    s_add_u32 s50, s50, 114688
    s_and_b32 s51, s5, 24
    s_add_u32 s51, s51, s3
    s_lshl3_add_u32 s51, s51, s49
    s_lshl_b32 s51, s51, 8
    buffer_load_dword v80, v156, s[8:11], s50 offen offset:0 sc1
L_g_32:
    s_waitcnt vmcnt(0)
    v_cmp_ne_u32_sdwa vcc, v80, v146 src0_sel:WORD_0 src1_sel:WORD_0
    s_cbranch_vccnz L_gr_34
    ds_write_b16_d16_hi v148, v80 offset:2048
    v_mov_b32 v15, 2
    ds_write_b32 v6, v15 offset:320
L_cs_36:
    ds_read_b32 v15, v5 offset:320
    s_sub_u32 s48, s48, 1
    s_cbranch_scc1 L_end
    s_waitcnt lgkmcnt(0)
    v_cmp_gt_u32 vcc, 2, v15
    s_cbranch_vccnz L_cs_36
    ds_read_b128 v[80:83], v3 offset:2048
    ds_read_b128 v[84:87], v3 offset:2304
    ds_read_b128 v[88:91], v3 offset:2560
    ds_read_b128 v[92:95], v3 offset:2816
    s_waitcnt lgkmcnt(3)
    v_mfma_f32_16x16x32_bf16 v[136:139], v[112:115], v[80:83], 0
    s_waitcnt lgkmcnt(2)
    v_mfma_f32_16x16x32_bf16 v[136:139], v[116:119], v[84:87], v[136:139]
    s_waitcnt lgkmcnt(1)
    v_mfma_f32_16x16x32_bf16 v[136:139], v[120:123], v[88:91], v[136:139]
    s_waitcnt lgkmcnt(0)
    v_mfma_f32_16x16x32_bf16 v[136:139], v[124:127], v[92:95], v[136:139]
    s_cmp_eq_u32 s37, 0
    s_nop 6
    v_bfi_b32 v136, s7, v145, v136
    v_bfi_b32 v137, s7, v145, v137
    s_cbranch_scc1 L_sg_37
    buffer_store_dwordx4 v[136:139], v4, s[12:15], s51 offen
L_sd_38:
    s_add_u32 s49, s54, 1
    s_cmp_ge_i32 s53, s49
    s_cbranch_scc1 L_wd_40
L_wl_39:
    ds_read_b32 v15, v1 offset:0
    s_sub_u32 s48, s48, 1
    s_cbranch_scc1 L_end
    s_waitcnt lgkmcnt(0)
    v_readfirstlane_b32 s53, v15
    s_nop 0
    s_cmp_lt_i32 s53, s49
    s_cbranch_scc1 L_wl_39
L_wd_40:
    s_and_b32 s49, s54, 15
    s_lshl_b32 s49, s49, 13
    s_add_u32 s49, s49, 32768
    v_add_u32 v8, s49, v151
    v_xor_b32 v9, 64, v8
    v_xor_b32 v10, 0x80, v8
    v_xor_b32 v11, 0xc0, v8
    ds_read_b128 v[48:51], v8 offset:0
    ds_read_b128 v[52:55], v9 offset:0
    ds_read_b128 v[56:59], v10 offset:0
    ds_read_b128 v[60:63], v11 offset:0
    ds_read_b128 v[64:67], v8 offset:4096
    ds_read_b128 v[68:71], v9 offset:4096
    ds_read_b128 v[72:75], v10 offset:4096
    ds_read_b128 v[76:79], v11 offset:4096
    s_add_u32 s54, s54, 8
    s_waitcnt lgkmcnt(0)
    v_mov_b32 v15, s54
    ds_write_b32 v6, v15 offset:256
    s_cmp_lg_u32 s3, 0
    s_cbranch_scc1 L_noq
    s_lshl_b32 s50, s5, 11
    s_lshl_b32 s51, s4, 5
    s_add_u32 s51, s51, s5
    s_lshl_b32 s51, s51, 6
    s_add_u32 s51, s51, 163840
    v_lshlrev_b32 v8, 14, v154
    v_lshl_add_u32 v8, v155, 2, v8
    buffer_load_dwordx4 v[80:83], v150, s[12:15], s50 offen offset:0 sc1
    buffer_load_dwordx4 v[84:87], v150, s[12:15], s50 offen offset:1024 sc1
L_g_41:
    s_waitcnt vmcnt(0)
    v_bitop3_b32 v14, v80, v81, v146 bitop3:0x7e
    v_cmp_ne_u32_sdwa s[20:21], v14, v147 src0_sel:BYTE_0 src1_sel:DWORD
    v_bitop3_b32 v15, v84, v85, v146 bitop3:0x7e
    v_cmp_ne_u32_sdwa s[22:23], v15, v147 src0_sel:BYTE_0 src1_sel:DWORD
    s_nop 0
    s_or_b64 vcc, s[20:21], s[22:23]
    s_cbranch_scc1 L_gr_43
    v_and_b32 v80, s45, v80
    v_and_b32 v81, s45, v81
    v_and_b32 v84, s45, v84
    v_and_b32 v85, s45, v85
    v_pk_add_f32 v[80:81], v[80:81], v[84:85]
    v_pk_add_f32 v[82:83], v[82:83], v[86:87]
    s_nop 1
    v_permlane32_swap_b32 v80, v82
    v_permlane32_swap_b32 v81, v83
    v_add_f32 v80, v80, v82
    v_add_f32 v81, v81, v83
    s_nop 1
    v_permlane16_swap_b32 v80, v81
    v_add_f32 v80, v80, v81
    v_cvt_pk_bf16_f32 v80, v80, v80
    v_bfi_b32 v80, s36, v146, v80
    buffer_store_dword v80, v8, s[8:11], s51 offen sc1
L_noq:
    s_add_u32 s49, s54, 1
    s_cmp_ge_i32 s53, s49
    s_cbranch_scc1 L_wd_47
L_wl_46:
    ds_read_b32 v15, v1 offset:0
    s_sub_u32 s48, s48, 1
    s_cbranch_scc1 L_end
    s_waitcnt lgkmcnt(0)
    v_readfirstlane_b32 s53, v15
    s_nop 0
    s_cmp_lt_i32 s53, s49
    s_cbranch_scc1 L_wl_46
L_wd_47:
    s_and_b32 s49, s54, 15
    s_lshl_b32 s49, s49, 13
    s_add_u32 s49, s49, 32768
    v_add_u32 v8, s49, v151
    v_xor_b32 v9, 64, v8
    v_xor_b32 v10, 0x80, v8
    v_xor_b32 v11, 0xc0, v8
    ds_read_b128 v[80:83], v8 offset:0
    ds_read_b128 v[84:87], v9 offset:0
    ds_read_b128 v[88:91], v10 offset:0
    ds_read_b128 v[92:95], v11 offset:0
    ds_read_b128 v[96:99], v8 offset:4096
    ds_read_b128 v[100:103], v9 offset:4096
    ds_read_b128 v[104:107], v10 offset:4096
    ds_read_b128 v[108:111], v11 offset:4096
    s_add_u32 s54, s54, 8
    s_waitcnt lgkmcnt(0)
    v_mov_b32 v15, s54
    ds_write_b32 v6, v15 offset:256
    s_cmp_lt_u32 s2, 192
    s_cselect_b32 s49, 38, 38
    s_and_b32 s50, s5, 3
    s_add_u32 s49, s49, s50
    s_cmp_ge_i32 s53, s49
    s_cbranch_scc1 L_wd_49
L_wl_48:
    ds_read_b32 v15, v1 offset:0
    s_sub_u32 s48, s48, 1
    s_cbranch_scc1 L_end
    s_waitcnt lgkmcnt(0)
    v_readfirstlane_b32 s53, v15
    s_nop 0
    s_cmp_lt_i32 s53, s49
    s_cbranch_scc1 L_wl_48
L_wd_49:
    s_lshr_b32 s55, s5, 4
    s_lshl1_add_u32 s49, s4, s55
    s_and_b32 s56, s49, 3
    s_lshr_b32 s57, s49, 2
    s_and_b32 s44, s5, 15
    s_lshl3_add_u32 s49, s57, s3
    s_lshl_b32 s49, s49, 9
    s_lshl_b32 s50, s56, 14
    s_add_u32 s49, s49, s50
    s_add_u32 s49, s49, 163840
    v_lshlrev_b32 v10, 6, v154
    v_lshl_add_u32 v10, v155, 2, v10
    s_mul_i32 s50, s3, 272
    v_lshrrev_b32 v8, 1, v156
    v_add_u32 v8, s50, v8
    v_mul_u32_u24 v9, 68, v5
    v_lshl_add_u32 v9, v152, 4, v9
    buffer_load_dword v128, v10, s[8:11], s49 offen offset:0 sc1
    buffer_load_dword v129, v10, s[8:11], s49 offen offset:256 sc1
L_g_50:
    s_waitcnt vmcnt(0)
    v_cmp_ne_u32_sdwa s[20:21], v128, v146 src0_sel:WORD_0 src1_sel:WORD_0
    v_cmp_ne_u32_sdwa s[22:23], v129, v146 src0_sel:WORD_0 src1_sel:WORD_0
    s_nop 0
    s_or_b64 vcc, s[20:21], s[22:23]
    s_cbranch_scc1 L_gr_52
    ds_write_b16_d16_hi v8, v128 offset:5120
    ds_write_b16_d16_hi v8, v129 offset:5248
    v_mov_b32 v15, 3
    ds_write_b32 v6, v15 offset:320
L_cs_55:
    ds_read_b32 v15, v5 offset:320
    s_sub_u32 s48, s48, 1
    s_cbranch_scc1 L_end
    s_waitcnt lgkmcnt(0)
    v_cmp_gt_u32 vcc, 3, v15
    s_cbranch_vccnz L_cs_55
    ds_read_b128 v[112:115], v9 offset:5120
    ds_read_b128 v[116:119], v9 offset:5184
    ds_read_b128 v[120:123], v9 offset:5248
    ds_read_b128 v[124:127], v9 offset:5312
    s_waitcnt lgkmcnt(0)
    v_mfma_f32_16x16x32_bf16 v[128:131], v[16:19], v[112:115], 0
    v_mfma_f32_16x16x32_bf16 v[132:135], v[32:35], v[112:115], 0
    v_mfma_f32_16x16x32_bf16 v[128:131], v[20:23], v[116:119], v[128:131]
    v_mfma_f32_16x16x32_bf16 v[132:135], v[36:39], v[116:119], v[132:135]
    v_mfma_f32_16x16x32_bf16 v[128:131], v[24:27], v[120:123], v[128:131]
    v_mfma_f32_16x16x32_bf16 v[132:135], v[40:43], v[120:123], v[132:135]
    v_mfma_f32_16x16x32_bf16 v[128:131], v[28:31], v[124:127], v[128:131]
    v_mfma_f32_16x16x32_bf16 v[132:135], v[44:47], v[124:127], v[132:135]
    s_nop 6
    v_cvt_pk_bf16_f32 v129, v128, v129
    v_lshlrev_b32 v128, 16, v129
    v_and_b32 v129, 0xffff0000, v129
    v_mul_f32 v128, 0x3db504f3, v128
    v_mul_f32 v129, 0x3db504f3, v129
    v_cvt_pk_bf16_f32 v129, v128, v129
    v_lshlrev_b32 v128, 16, v129
    v_and_b32 v129, 0xffff0000, v129
    v_max_f32 v149, v128, v129
    v_cvt_pk_bf16_f32 v131, v130, v131
    v_lshlrev_b32 v130, 16, v131
    v_and_b32 v131, 0xffff0000, v131
    v_mul_f32 v130, 0x3db504f3, v130
    v_mul_f32 v131, 0x3db504f3, v131
    v_cvt_pk_bf16_f32 v131, v130, v131
    v_lshlrev_b32 v130, 16, v131
    v_and_b32 v131, 0xffff0000, v131
    v_max3_f32 v149, v149, v130, v131
    v_cvt_pk_bf16_f32 v133, v132, v133
    v_lshlrev_b32 v132, 16, v133
    v_and_b32 v133, 0xffff0000, v133
    v_mul_f32 v132, 0x3db504f3, v132
    v_mul_f32 v133, 0x3db504f3, v133
    v_cvt_pk_bf16_f32 v133, v132, v133
    v_lshlrev_b32 v132, 16, v133
    v_and_b32 v133, 0xffff0000, v133
    v_max3_f32 v149, v149, v132, v133
    v_cvt_pk_bf16_f32 v135, v134, v135
    v_lshlrev_b32 v134, 16, v135
    v_and_b32 v135, 0xffff0000, v135
    v_mul_f32 v134, 0x3db504f3, v134
    v_mul_f32 v135, 0x3db504f3, v135
    v_cvt_pk_bf16_f32 v135, v134, v135
    v_lshlrev_b32 v134, 16, v135
    v_and_b32 v135, 0xffff0000, v135
    v_max3_f32 v149, v149, v134, v135
    v_mfma_f32_16x16x32_bf16 v[16:19], v[48:51], v[112:115], 0
    v_mfma_f32_16x16x32_bf16 v[20:23], v[64:67], v[112:115], 0
    v_mfma_f32_16x16x32_bf16 v[16:19], v[52:55], v[116:119], v[16:19]
    v_mfma_f32_16x16x32_bf16 v[20:23], v[68:71], v[116:119], v[20:23]
    v_mfma_f32_16x16x32_bf16 v[16:19], v[56:59], v[120:123], v[16:19]
    v_mfma_f32_16x16x32_bf16 v[20:23], v[72:75], v[120:123], v[20:23]
    v_mfma_f32_16x16x32_bf16 v[16:19], v[60:63], v[124:127], v[16:19]
    v_mfma_f32_16x16x32_bf16 v[20:23], v[76:79], v[124:127], v[20:23]
    s_nop 6
    v_cvt_pk_bf16_f32 v17, v16, v17
    v_lshlrev_b32 v16, 16, v17
    v_and_b32 v17, 0xffff0000, v17
    v_mul_f32 v16, 0x3db504f3, v16
    v_mul_f32 v17, 0x3db504f3, v17
    v_cvt_pk_bf16_f32 v17, v16, v17
    v_lshlrev_b32 v16, 16, v17
    v_and_b32 v17, 0xffff0000, v17
    v_max3_f32 v149, v149, v16, v17
    v_cvt_pk_bf16_f32 v19, v18, v19
    v_lshlrev_b32 v18, 16, v19
    v_and_b32 v19, 0xffff0000, v19
    v_mul_f32 v18, 0x3db504f3, v18
    v_mul_f32 v19, 0x3db504f3, v19
    v_cvt_pk_bf16_f32 v19, v18, v19
    v_lshlrev_b32 v18, 16, v19
    v_and_b32 v19, 0xffff0000, v19
    v_max3_f32 v149, v149, v18, v19
    v_cvt_pk_bf16_f32 v21, v20, v21
    v_lshlrev_b32 v20, 16, v21
    v_and_b32 v21, 0xffff0000, v21
    v_mul_f32 v20, 0x3db504f3, v20
    v_mul_f32 v21, 0x3db504f3, v21
    v_cvt_pk_bf16_f32 v21, v20, v21
    v_lshlrev_b32 v20, 16, v21
    v_and_b32 v21, 0xffff0000, v21
    v_max3_f32 v149, v149, v20, v21
    v_cvt_pk_bf16_f32 v23, v22, v23
    v_lshlrev_b32 v22, 16, v23
    v_and_b32 v23, 0xffff0000, v23
    v_mul_f32 v22, 0x3db504f3, v22
    v_mul_f32 v23, 0x3db504f3, v23
    v_cvt_pk_bf16_f32 v23, v22, v23
    v_lshlrev_b32 v22, 16, v23
    v_and_b32 v23, 0xffff0000, v23
    v_max3_f32 v149, v149, v22, v23
    v_mfma_f32_16x16x32_bf16 v[24:27], v[80:83], v[112:115], 0
    v_mfma_f32_16x16x32_bf16 v[28:31], v[96:99], v[112:115], 0
    v_mfma_f32_16x16x32_bf16 v[24:27], v[84:87], v[116:119], v[24:27]
    v_mfma_f32_16x16x32_bf16 v[28:31], v[100:103], v[116:119], v[28:31]
    v_mfma_f32_16x16x32_bf16 v[24:27], v[88:91], v[120:123], v[24:27]
    v_mfma_f32_16x16x32_bf16 v[28:31], v[104:107], v[120:123], v[28:31]
    v_mfma_f32_16x16x32_bf16 v[24:27], v[92:95], v[124:127], v[24:27]
    v_mfma_f32_16x16x32_bf16 v[28:31], v[108:111], v[124:127], v[28:31]
    s_nop 6
    v_cvt_pk_bf16_f32 v25, v24, v25
    v_lshlrev_b32 v24, 16, v25
    v_and_b32 v25, 0xffff0000, v25
    v_mul_f32 v24, 0x3db504f3, v24
    v_mul_f32 v25, 0x3db504f3, v25
    v_cvt_pk_bf16_f32 v25, v24, v25
    v_lshlrev_b32 v24, 16, v25
    v_and_b32 v25, 0xffff0000, v25
    v_max3_f32 v149, v149, v24, v25
    v_cvt_pk_bf16_f32 v27, v26, v27
    v_lshlrev_b32 v26, 16, v27
    v_and_b32 v27, 0xffff0000, v27
    v_mul_f32 v26, 0x3db504f3, v26
    v_mul_f32 v27, 0x3db504f3, v27
    v_cvt_pk_bf16_f32 v27, v26, v27
    v_lshlrev_b32 v26, 16, v27
    v_and_b32 v27, 0xffff0000, v27
    v_max3_f32 v149, v149, v26, v27
    v_cvt_pk_bf16_f32 v29, v28, v29
    v_lshlrev_b32 v28, 16, v29
    v_and_b32 v29, 0xffff0000, v29
    v_mul_f32 v28, 0x3db504f3, v28
    v_mul_f32 v29, 0x3db504f3, v29
    v_cvt_pk_bf16_f32 v29, v28, v29
    v_lshlrev_b32 v28, 16, v29
    v_and_b32 v29, 0xffff0000, v29
    v_max3_f32 v149, v149, v28, v29
    v_cvt_pk_bf16_f32 v31, v30, v31
    v_lshlrev_b32 v30, 16, v31
    v_and_b32 v31, 0xffff0000, v31
    v_mul_f32 v30, 0x3db504f3, v30
    v_mul_f32 v31, 0x3db504f3, v31
    v_cvt_pk_bf16_f32 v31, v30, v31
    v_lshlrev_b32 v30, 16, v31
    v_and_b32 v31, 0xffff0000, v31
    v_max3_f32 v149, v149, v30, v31
    s_add_u32 s49, s54, 1
    s_cmp_ge_i32 s53, s49
    s_cbranch_scc1 L_wd_57
L_wl_56:
    ds_read_b32 v15, v1 offset:0
    s_sub_u32 s48, s48, 1
    s_cbranch_scc1 L_end
    s_waitcnt lgkmcnt(0)
    v_readfirstlane_b32 s53, v15
    s_nop 0
    s_cmp_lt_i32 s53, s49
    s_cbranch_scc1 L_wl_56
L_wd_57:
    s_and_b32 s49, s54, 15
    s_lshl_b32 s49, s49, 13
    s_add_u32 s49, s49, 32768
    v_add_u32 v8, s49, v151
    v_xor_b32 v9, 64, v8
    v_xor_b32 v10, 0x80, v8
    v_xor_b32 v11, 0xc0, v8
    ds_read_b128 v[48:51], v8 offset:0
    ds_read_b128 v[52:55], v9 offset:0
    ds_read_b128 v[56:59], v10 offset:0
    ds_read_b128 v[60:63], v11 offset:0
    ds_read_b128 v[64:67], v8 offset:4096
    ds_read_b128 v[68:71], v9 offset:4096
    ds_read_b128 v[72:75], v10 offset:4096
    ds_read_b128 v[76:79], v11 offset:4096
    s_mov_b32 s54, 44
    s_waitcnt lgkmcnt(0)
    v_mov_b32 v15, s54
    ds_write_b32 v6, v15 offset:256
    v_mfma_f32_16x16x32_bf16 v[32:35], v[48:51], v[112:115], 0
    v_mfma_f32_16x16x32_bf16 v[36:39], v[64:67], v[112:115], 0
    v_mfma_f32_16x16x32_bf16 v[32:35], v[52:55], v[116:119], v[32:35]
    v_mfma_f32_16x16x32_bf16 v[36:39], v[68:71], v[116:119], v[36:39]
    v_mfma_f32_16x16x32_bf16 v[32:35], v[56:59], v[120:123], v[32:35]
    v_mfma_f32_16x16x32_bf16 v[36:39], v[72:75], v[120:123], v[36:39]
    v_mfma_f32_16x16x32_bf16 v[32:35], v[60:63], v[124:127], v[32:35]
    v_mfma_f32_16x16x32_bf16 v[36:39], v[76:79], v[124:127], v[36:39]
    s_nop 6
    v_cvt_pk_bf16_f32 v33, v32, v33
    v_lshlrev_b32 v32, 16, v33
    v_and_b32 v33, 0xffff0000, v33
    v_mul_f32 v32, 0x3db504f3, v32
    v_mul_f32 v33, 0x3db504f3, v33
    v_cvt_pk_bf16_f32 v33, v32, v33
    v_lshlrev_b32 v32, 16, v33
    v_and_b32 v33, 0xffff0000, v33
    v_max3_f32 v149, v149, v32, v33
    v_cvt_pk_bf16_f32 v35, v34, v35
    v_lshlrev_b32 v34, 16, v35
    v_and_b32 v35, 0xffff0000, v35
    v_mul_f32 v34, 0x3db504f3, v34
    v_mul_f32 v35, 0x3db504f3, v35
    v_cvt_pk_bf16_f32 v35, v34, v35
    v_lshlrev_b32 v34, 16, v35
    v_and_b32 v35, 0xffff0000, v35
    v_max3_f32 v149, v149, v34, v35
    v_cvt_pk_bf16_f32 v37, v36, v37
    v_lshlrev_b32 v36, 16, v37
    v_and_b32 v37, 0xffff0000, v37
    v_mul_f32 v36, 0x3db504f3, v36
    v_mul_f32 v37, 0x3db504f3, v37
    v_cvt_pk_bf16_f32 v37, v36, v37
    v_lshlrev_b32 v36, 16, v37
    v_and_b32 v37, 0xffff0000, v37
    v_max3_f32 v149, v149, v36, v37
    v_cvt_pk_bf16_f32 v39, v38, v39
    v_lshlrev_b32 v38, 16, v39
    v_and_b32 v39, 0xffff0000, v39
    v_mul_f32 v38, 0x3db504f3, v38
    v_mul_f32 v39, 0x3db504f3, v39
    v_cvt_pk_bf16_f32 v39, v38, v39
    v_lshlrev_b32 v38, 16, v39
    v_and_b32 v39, 0xffff0000, v39
    v_max3_f32 v149, v149, v38, v39
    v_mov_b32 v8, v149
    s_nop 1
    v_permlane32_swap_b32 v149, v8
    v_max_f32 v149, v149, v8
    v_mov_b32 v8, v149
    s_nop 1
    v_permlane16_swap_b32 v149, v8
    v_max_f32 v149, v149, v8
    v_lshlrev_b32 v9, 3, v5
    v_add_u32 v10, v9, v6
    ds_write_b32 v10, v149 offset:768
    v_mov_b32 v15, 4
    ds_write_b32 v6, v15 offset:320
L_cs_58:
    ds_read_b32 v15, v5 offset:320
    s_sub_u32 s48, s48, 1
    s_cbranch_scc1 L_end
    s_waitcnt lgkmcnt(0)
    v_cmp_gt_u32 vcc, 4, v15
    s_cbranch_vccnz L_cs_58
    ds_read_b128 v[80:83], v9 offset:768
    ds_read_b128 v[84:87], v9 offset:784
    s_waitcnt lgkmcnt(0)
    v_max3_f32 v149, v80, v81, v82
    v_max3_f32 v149, v149, v83, v84
    v_max3_f32 v149, v149, v85, v86
    v_max_f32 v149, v149, v87
    s_lshl_b32 s49, s3, 9
    v_add_u32 v11, s49, v7
    v_sub_f32 v128, v128, v149
    v_mul_f32 v128, 0x3fb8aa3b, v128
    v_exp_f32 v128, v128
    v_sub_f32 v129, v129, v149
    v_mul_f32 v129, 0x3fb8aa3b, v129
    v_exp_f32 v129, v129
    v_sub_f32 v130, v130, v149
    v_mul_f32 v130, 0x3fb8aa3b, v130
    v_exp_f32 v130, v130
    v_sub_f32 v131, v131, v149
    v_mul_f32 v131, 0x3fb8aa3b, v131
    v_exp_f32 v131, v131
    v_sub_f32 v132, v132, v149
    v_mul_f32 v132, 0x3fb8aa3b, v132
    v_exp_f32 v132, v132
    v_sub_f32 v133, v133, v149
    v_mul_f32 v133, 0x3fb8aa3b, v133
    v_exp_f32 v133, v133
    v_sub_f32 v134, v134, v149
    v_mul_f32 v134, 0x3fb8aa3b, v134
    v_exp_f32 v134, v134
    v_sub_f32 v135, v135, v149
    v_mul_f32 v135, 0x3fb8aa3b, v135
    v_exp_f32 v135, v135
    v_add_f32 v8, v128, v129
    v_add_f32 v8, v8, v130
    v_add_f32 v8, v8, v131
    v_add_f32 v8, v8, v132
    v_add_f32 v8, v8, v133
    v_add_f32 v8, v8, v134
    v_add_f32 v8, v8, v135
    v_cvt_pk_bf16_f32 v80, v128, v129
    v_cvt_pk_bf16_f32 v81, v130, v131
    v_cvt_pk_bf16_f32 v82, v132, v133
    v_cvt_pk_bf16_f32 v83, v134, v135
    ds_write_b128 v11, v[80:83] offset:16384
    v_sub_f32 v16, v16, v149
    v_mul_f32 v16, 0x3fb8aa3b, v16
    v_exp_f32 v16, v16
    v_sub_f32 v17, v17, v149
    v_mul_f32 v17, 0x3fb8aa3b, v17
    v_exp_f32 v17, v17
    v_sub_f32 v18, v18, v149
    v_mul_f32 v18, 0x3fb8aa3b, v18
    v_exp_f32 v18, v18
    v_sub_f32 v19, v19, v149
    v_mul_f32 v19, 0x3fb8aa3b, v19
    v_exp_f32 v19, v19
    v_sub_f32 v20, v20, v149
    v_mul_f32 v20, 0x3fb8aa3b, v20
    v_exp_f32 v20, v20
    v_sub_f32 v21, v21, v149
    v_mul_f32 v21, 0x3fb8aa3b, v21
    v_exp_f32 v21, v21
    v_sub_f32 v22, v22, v149
    v_mul_f32 v22, 0x3fb8aa3b, v22
    v_exp_f32 v22, v22
    v_sub_f32 v23, v23, v149
    v_mul_f32 v23, 0x3fb8aa3b, v23
    v_exp_f32 v23, v23
    v_add_f32 v8, v8, v16
    v_add_f32 v8, v8, v17
    v_add_f32 v8, v8, v18
    v_add_f32 v8, v8, v19
    v_add_f32 v8, v8, v20
    v_add_f32 v8, v8, v21
    v_add_f32 v8, v8, v22
    v_add_f32 v8, v8, v23
    v_cvt_pk_bf16_f32 v84, v16, v17
    v_cvt_pk_bf16_f32 v85, v18, v19
    v_cvt_pk_bf16_f32 v86, v20, v21
    v_cvt_pk_bf16_f32 v87, v22, v23
    ds_write_b128 v11, v[84:87] offset:20480
    v_sub_f32 v24, v24, v149
    v_mul_f32 v24, 0x3fb8aa3b, v24
    v_exp_f32 v24, v24
    v_sub_f32 v25, v25, v149
    v_mul_f32 v25, 0x3fb8aa3b, v25
    v_exp_f32 v25, v25
    v_sub_f32 v26, v26, v149
    v_mul_f32 v26, 0x3fb8aa3b, v26
    v_exp_f32 v26, v26
    v_sub_f32 v27, v27, v149
    v_mul_f32 v27, 0x3fb8aa3b, v27
    v_exp_f32 v27, v27
    v_sub_f32 v28, v28, v149
    v_mul_f32 v28, 0x3fb8aa3b, v28
    v_exp_f32 v28, v28
    v_sub_f32 v29, v29, v149
    v_mul_f32 v29, 0x3fb8aa3b, v29
    v_exp_f32 v29, v29
    v_sub_f32 v30, v30, v149
    v_mul_f32 v30, 0x3fb8aa3b, v30
    v_exp_f32 v30, v30
    v_sub_f32 v31, v31, v149
    v_mul_f32 v31, 0x3fb8aa3b, v31
    v_exp_f32 v31, v31
    v_add_f32 v8, v8, v24
    v_add_f32 v8, v8, v25
    v_add_f32 v8, v8, v26
    v_add_f32 v8, v8, v27
    v_add_f32 v8, v8, v28
    v_add_f32 v8, v8, v29
    v_add_f32 v8, v8, v30
    v_add_f32 v8, v8, v31
    v_cvt_pk_bf16_f32 v88, v24, v25
    v_cvt_pk_bf16_f32 v89, v26, v27
    v_cvt_pk_bf16_f32 v90, v28, v29
    v_cvt_pk_bf16_f32 v91, v30, v31
    ds_write_b128 v11, v[88:91] offset:24576
    v_sub_f32 v32, v32, v149
    v_mul_f32 v32, 0x3fb8aa3b, v32
    v_exp_f32 v32, v32
    v_sub_f32 v33, v33, v149
    v_mul_f32 v33, 0x3fb8aa3b, v33
    v_exp_f32 v33, v33
    v_sub_f32 v34, v34, v149
    v_mul_f32 v34, 0x3fb8aa3b, v34
    v_exp_f32 v34, v34
    v_sub_f32 v35, v35, v149
    v_mul_f32 v35, 0x3fb8aa3b, v35
    v_exp_f32 v35, v35
    v_sub_f32 v36, v36, v149
    v_mul_f32 v36, 0x3fb8aa3b, v36
    v_exp_f32 v36, v36
    v_sub_f32 v37, v37, v149
    v_mul_f32 v37, 0x3fb8aa3b, v37
    v_exp_f32 v37, v37
    v_sub_f32 v38, v38, v149
    v_mul_f32 v38, 0x3fb8aa3b, v38
    v_exp_f32 v38, v38
    v_sub_f32 v39, v39, v149
    v_mul_f32 v39, 0x3fb8aa3b, v39
    v_exp_f32 v39, v39
    v_add_f32 v8, v8, v32
    v_add_f32 v8, v8, v33
    v_add_f32 v8, v8, v34
    v_add_f32 v8, v8, v35
    v_add_f32 v8, v8, v36
    v_add_f32 v8, v8, v37
    v_add_f32 v8, v8, v38
    v_add_f32 v8, v8, v39
    v_cvt_pk_bf16_f32 v92, v32, v33
    v_cvt_pk_bf16_f32 v93, v34, v35
    v_cvt_pk_bf16_f32 v94, v36, v37
    v_cvt_pk_bf16_f32 v95, v38, v39
    ds_write_b128 v11, v[92:95] offset:28672
    v_mov_b32 v12, v8
    s_nop 1
    v_permlane32_swap_b32 v8, v12
    v_add_f32 v8, v8, v12
    v_mov_b32 v12, v8
    s_nop 1
    v_permlane16_swap_b32 v8, v12
    v_add_f32 v8, v8, v12
    ds_write_b32 v10, v8 offset:1024
    v_mov_b32 v15, 5
    ds_write_b32 v6, v15 offset:320
L_cs_59:
    ds_read_b32 v15, v5 offset:320
    s_sub_u32 s48, s48, 1
    s_cbranch_scc1 L_end
    s_waitcnt lgkmcnt(0)
    v_cmp_gt_u32 vcc, 5, v15
    s_cbranch_vccnz L_cs_59
    ds_read_b128 v[80:83], v9 offset:1024
    ds_read_b128 v[84:87], v9 offset:1040
    s_waitcnt lgkmcnt(0)
    s_cmp_lg_u32 s3, 0
    s_cbranch_scc1 L_noml
    v_pk_add_f32 v[80:81], v[80:81], v[84:85]
    v_pk_add_f32 v[82:83], v[82:83], v[86:87]
    v_pk_add_f32 v[80:81], v[80:81], v[82:83]
    v_add_f32 v80, v80, v81
    v_bfi_b32 v80, s7, v146, v80
    v_bfi_b32 v81, s7, v146, v149
    s_lshl_b32 s49, s5, 6
    s_add_u32 s49, s49, 196608
    v_lshlrev_b32 v8, 3, v0
    s_mov_b64 exec, 0xff
    s_cmp_eq_u32 s37, 0
    s_cbranch_scc1 L_sg_60
    buffer_store_dwordx2 v[80:81], v8, s[12:15], s49 offen
L_sd_61:
    s_mov_b64 exec, -1
L_noml:
    v_add_u32 v8, 131072, v2
    s_cmp_ge_i32 s53, 48
    s_cbranch_scc1 L_wd_63
L_wl_62:
    ds_read_b32 v15, v1 offset:0
    s_sub_u32 s48, s48, 1
    s_cbranch_scc1 L_end
    s_waitcnt lgkmcnt(0)
    v_readfirstlane_b32 s53, v15
    s_nop 0
    s_cmp_lt_i32 s53, 48
    s_cbranch_scc1 L_wl_62
L_wd_63:
    ds_read_b64_tr_b16 v[112:113], v8 offset:0
    ds_read_b64_tr_b16 v[114:115], v8 offset:4096
    ds_read_b64_tr_b16 v[116:117], v8 offset:8192
    ds_read_b64_tr_b16 v[118:119], v8 offset:12288
    ds_read_b64_tr_b16 v[120:121], v8 offset:16384
    ds_read_b64_tr_b16 v[122:123], v8 offset:20480
    ds_read_b64_tr_b16 v[124:125], v8 offset:24576
    ds_read_b64_tr_b16 v[126:127], v8 offset:28672
    s_mov_b32 s54, 48
L_nowo:
    s_add_u32 s47, s54, 32
    s_add_u32 s58, s54, 10
    s_and_b32 s49, s5, 7
    s_add_u32 s58, s58, s49
    v_mov_b32 v136, 0
    v_mov_b32 v137, 0
    v_mov_b32 v138, 0
    v_mov_b32 v139, 0
L_v_64:
    s_and_b32 s50, s54, 15
    s_lshl_b32 s50, s50, 13
    s_add_u32 s50, s50, 32768
    v_add_u32 v8, s50, v2
    s_add_u32 s54, s54, 1
    ds_read_b128 v[20:23], v7 offset:16384
    v_add_u32 v7, 512, v7
L_vp_65:
    ds_read_b32 v14, v1 offset:0
    ds_read_b64_tr_b16 v[16:17], v8 offset:0
    ds_read_b64_tr_b16 v[18:19], v8 offset:4096
    s_sub_u32 s48, s48, 1
    s_cbranch_scc1 L_end
    v_mov_b32 v15, s54
    s_waitcnt lgkmcnt(0)
    v_cmp_gt_i32 vcc, s54, v14
    s_cmp_lt_u32 s54, s58
    s_cbranch_vccnz L_vp_65
    v_mfma_f32_16x16x32_bf16 v[136:139], v[16:19], v[20:23], v[136:139]
    ds_write_b32 v6, v15 offset:256
    s_cbranch_scc1 L_v_64
    s_and_b32 s59, s5, 3
    s_lshl_b32 s49, s55, 10
    s_add_u32 s49, s49, 196608
    v_lshlrev_b32 v8, 3, v0
    v_lshrrev_b32 v9, 2, v0
    v_lshlrev_b32 v81, 8, v9
    v_lshl_add_u32 v81, v153, 4, v81
    s_cmp_ge_u32 s2, 224
    s_cbranch_scc1 L_preR
    s_lshl3_add_u32 s51, s59, s3
    s_lshl_b32 s51, s51, 10
    s_add_u32 s51, s51, 131072
    buffer_load_dwordx2 v[24:25], v8, s[12:15], s49 offen sc1
    buffer_load_dwordx2 v[26:27], v8, s[12:15], s49 offen offset:512 sc1
    buffer_load_dwordx2 v[48:49], v8, s[8:11], s51 offen offset:0 sc1
    buffer_load_dwordx2 v[50:51], v8, s[8:11], s51 offen offset:512 sc1
L_g_66:
    s_waitcnt vmcnt(0)
    v_bitop3_b32 v14, v24, v25, v146 bitop3:0x7e
    v_cmp_ne_u32_sdwa s[20:21], v14, v147 src0_sel:BYTE_0 src1_sel:DWORD
    v_bitop3_b32 v15, v26, v27, v146 bitop3:0x7e
    v_cmp_ne_u32_sdwa s[22:23], v15, v147 src0_sel:BYTE_0 src1_sel:DWORD
    v_cmp_ne_u32_sdwa s[24:25], v48, v146 src0_sel:WORD_0 src1_sel:WORD_0
    v_cmp_ne_u32_sdwa s[26:27], v50, v146 src0_sel:WORD_0 src1_sel:WORD_0
    s_or_b64 vcc, s[20:21], s[22:23]
    s_or_b64 vcc, vcc, s[24:25]
    s_or_b64 vcc, vcc, s[26:27]
    s_cbranch_scc1 L_gr_68
    v_and_b32 v24, s45, v24
    v_and_b32 v25, s45, v25
    v_and_b32 v26, s45, v26
    v_and_b32 v27, s45, v27
    v_and_b32 v48, 0xffff0000, v48
    v_and_b32 v50, 0xffff0000, v50
    v_mov_b32 v143, v48
    v_mov_b32 v144, v50
    v_and_b32 v141, 0xffff0000, v49
    v_and_b32 v142, 0xffff0000, v51
    s_branch L_preF
L_preR:
    s_lshr_b32 s50, s3, 2
    s_lshl1_add_u32 s50, s59, s50
    s_and_b32 s51, s3, 3
    s_lshl3_add_u32 s52, s4, s50
    s_lshl2_add_u32 s34, s52, s51
    s_lshl_b32 s34, s34, 6
    s_add_u32 s34, s34, 360448
    s_lshl_b32 s52, s52, 5
    s_lshl_b32 s19, s51, 11
    s_add_u32 s52, s52, s19
    v_lshl_add_u32 v96, v155, 1, s52
    global_load_ushort v142, v96, s[16:17]
    s_lshl_b32 s51, s51, 6
    s_lshl_b32 s19, s50, 13
    s_add_u32 s19, s19, s51
    s_add_u32 s19, s19, 131072
    buffer_load_dwordx2 v[24:25], v8, s[12:15], s49 offen sc1
    buffer_load_dwordx2 v[26:27], v8, s[12:15], s49 offen offset:512 sc1
L_g_73:
    s_waitcnt vmcnt(0)
    v_bitop3_b32 v14, v24, v25, v146 bitop3:0x7e
    v_cmp_ne_u32_sdwa s[20:21], v14, v147 src0_sel:BYTE_0 src1_sel:DWORD
    v_bitop3_b32 v15, v26, v27, v146 bitop3:0x7e
    v_cmp_ne_u32_sdwa s[22:23], v15, v147 src0_sel:BYTE_0 src1_sel:DWORD
    s_nop 0
    s_or_b64 vcc, s[20:21], s[22:23]
    s_cbranch_scc1 L_gr_75
    v_and_b32 v24, s45, v24
    v_and_b32 v25, s45, v25
    v_and_b32 v26, s45, v26
    v_and_b32 v27, s45, v27
    v_lshlrev_b32 v142, 16, v142
    v_add_u32 v82, 4096, v81
    v_cmp_gt_u32 vcc, 48, v0
    s_nop 1
    v_cndmask_b32 v97, 0, 1.0, vcc
    v_cndmask_b32 v86, v81, v82, vcc
    s_lshl3_add_u32 s49, s59, s3
    s_lshr_b32 s50, s49, 2
    s_and_b32 s51, s49, 3
    s_lshl_b32 s52, s50, 5
    s_add_u32 s52, s52, s51
    s_lshl_b32 s98, s52, 8
    s_lshl3_add_u32 s50, s50, s4
    s_lshl2_add_u32 s50, s50, s51
    s_lshl_b32 s50, s50, 7
    s_add_u32 s99, s50, 458752
    v_and_b32 v93, 0xff, v150
    v_lshl_add_u32 v93, v152, 11, v93
    s_sub_u32 s34, s34, 360448
    s_lshr_b32 s34, s34, 1
    s_add_u32 s34, s34, 491520
    v_lshrrev_b32 v9, 5, v0
    v_lshlrev_b32 v9, 2, v9
    v_lshl_add_u32 v89, v153, 3, v9
    v_and_b32 v9, 28, v0
    v_lshl_or_b32 v89, v9, 26, v89
L_preF:
    v_max_f32 v9, v25, v27
    s_nop 1
    v_max_f32_dpp v9, v9, v9 row_ror:8 row_mask:0xf bank_mask:0xf
    v_mov_b32 v12, v9
    s_nop 1
    v_permlane16_swap_b32 v9, v12
    v_max_f32 v9, v9, v12
    v_mov_b32 v12, v9
    s_nop 1
    v_permlane32_swap_b32 v9, v12
    v_max_f32 v9, v9, v12
    v_sub_f32 v25, v25, v9
    v_sub_f32 v27, v27, v9
    v_sub_f32 v149, v149, v9
    v_mul_f32 v25, 0x3fb8aa3b, v25
    v_mul_f32 v27, 0x3fb8aa3b, v27
    v_mul_f32 v149, 0x3fb8aa3b, v149
    v_exp_f32 v25, v25
    v_exp_f32 v27, v27
    v_exp_f32 v149, v149
    v_mul_f32 v9, v24, v25
    v_fmac_f32 v9, v26, v27
    s_nop 1
    v_add_f32_dpp v9, v9, v9 row_ror:8 row_mask:0xf bank_mask:0xf
    v_mov_b32 v12, v9
    s_nop 1
    v_permlane16_swap_b32 v9, v12
    v_add_f32 v9, v9, v12
    v_mov_b32 v12, v9
    s_nop 1
    v_permlane32_swap_b32 v9, v12
    v_add_f32 v9, v9, v12
    v_rcp_f32 v9, v9
    s_nop 0
    v_mul_f32 v140, v149, v9
    v_add_u32 v145, 13605, v145
    v_add_u32 v146, 13605, v146
    ds_read_b32 v15, v147 offset:292
    s_waitcnt lgkmcnt(0)
    v_readfirstlane_b32 s37, v15
    s_lshl3_add_u32 s49, s55, s3
    s_lshl_b32 s49, s49, 5
    s_add_u32 s49, s49, s44
    s_lshl_b32 s60, s49, 8
    v_and_b32 v80, 0xff, v4
    v_and_b32 v8, 1, v154
    v_lshl_or_b32 v80, v8, 12, v80
    v_and_b32 v8, 8, v0
    v_lshl_or_b32 v80, v8, 27, v80
    v_lshlrev_b32 v83, 2, v155
    v_lshl_or_b32 v85, v154, 29, v83
    s_lshl3_add_u32 s49, s59, s3
    s_lshl_b32 s61, s49, 12
    s_bfe_u32 s50, s49, 0x30001
    s_lshl3_add_u32 s50, s57, s50
    s_lshr_b32 s51, s59, 1
    s_and_b32 s52, s56, 2
    s_add_u32 s51, s51, s52
    s_lshl2_add_u32 s50, s50, s51
    s_and_b32 s51, s3, 1
    s_lshl1_add_u32 s50, s50, s51
    s_lshl_b32 s50, s50, 8
    s_add_u32 s16, s50, 229376
    s_lshl3_add_u32 s49, s5, s3
    s_lshl_b32 s49, s49, 8
    s_add_u32 s17, s49, 229376
    v_lshl_add_u32 v84, v154, 6, v83
    s_lshl_b32 s51, s51, 6
    v_lshl_add_u32 v9, v154, 4, v155
    v_add_u32 v9, s51, v9
    s_lshr_b32 s51, s3, 1
    v_mov_b32 v10, s51
    s_lshl_b32 s49, s3, 5
    s_add_u32 s50, s49, s5
    s_lshl_b32 s50, s50, 8
    s_add_u32 s18, s50, 131072
    s_sub_u32 s16, s16, 229376
    s_lshr_b32 s16, s16, 1
    s_add_u32 s16, s16, 425984
    s_sub_u32 s17, s17, 229376
    s_lshr_b32 s17, s17, 1
    s_add_u32 s17, s17, 425984
    v_and_b32 v84, 15, v0
    v_lshlrev_b32 v84, 3, v84
    v_lshrrev_b32 v9, 5, v0
    v_lshl_add_u32 v84, v9, 2, v84
    v_and_b32 v9, 16, v0
    v_lshl_or_b32 v84, v9, 26, v84
    s_and_b32 s51, s3, 1
    s_lshl_b32 s51, s51, 6
    v_lshl_add_u32 v9, v0, 2, s51
    v_lshrrev_b32 v98, 5, v9
    v_lshlrev_b32 v98, 8, v98
    v_bfe_u32 v14, v9, 2, 2
    v_lshl_add_u32 v98, v14, 6, v98
    v_lshl_add_u32 v98, v10, 4, v98
    v_bfe_u32 v14, v9, 4, 1
    v_lshl_add_u32 v98, v14, 3, v98
    v_and_b32 v14, 3, v9
    v_lshl_add_u32 v98, v14, 1, v98
    v_lshlrev_b32 v9, 3, v0
    v_add_u32 v9, 2048, v9
    v_cmp_gt_u32 vcc, 16, v0
    s_nop 1
    v_cndmask_b32 v98, v9, v98, vcc
    s_cmp_ge_u32 s2, 224
    s_cbranch_scc1 L_predone
    s_lshl_b32 s49, s3, 11
    s_add_u32 s35, s49, 360448
    s_lshl3_add_u32 s49, s59, s3
    s_lshl_b32 s49, s49, 9
    s_add_u32 s40, s49, 360448
    v_lshrrev_b32 v9, 2, v0
    v_lshlrev_b32 v82, 6, v9
    v_lshl_add_u32 v82, v153, 4, v82
    v_lshl_add_u32 v86, v154, 6, v83
    s_lshl_b32 s49, s3, 10
    v_lshlrev_b32 v88, 8, v153
    v_lshl_add_u32 v88, v154, 4, v88
    v_lshl_add_u32 v88, v152, 1, v88
    v_add_u32 v88, s49, v88
    ds_write_b16_d16_hi v88, v141 offset:8320
    ds_write_b16_d16_hi v88, v142 offset:8328
    ds_write_b16_d16_hi v88, v143 offset:8384
    ds_write_b16_d16_hi v88, v144 offset:8392
    v_cmp_gt_u32 vcc, 2, v154
    s_nop 1
    v_cndmask_b32 v100, 0, 1.0, vcc
    v_cmp_eq_u32 vcc, 2, v154
    v_mov_b32 v8, 0xba800000
    s_nop 0
    v_cndmask_b32 v101, 0, v8, vcc
    v_cmp_eq_u32 vcc, 3, v154
    s_nop 1
    v_cndmask_b32 v102, 0, 1.0, vcc
    v_lshlrev_b32 v89, 3, v154
    v_lshl_add_u32 v89, v6, 3, v89
    v_lshrrev_b32 v8, 5, v0
    v_lshl_add_u32 v89, v8, 2, v89
    v_and_b32 v90, 31, v0
    v_lshlrev_b32 v90, 3, v90
    v_mov_b32 v103, 0x3f803f80
    s_add_u32 s35, s49, 491520
    s_lshl3_add_u32 s50, s59, s3
    s_lshl_b32 s50, s50, 8
    s_add_u32 s40, s50, 491520
    v_bfe_u32 v9, v0, 1, 2
    v_lshlrev_b32 v89, 3, v9
    v_lshl_add_u32 v89, v6, 3, v89
    v_lshl_add_u32 v89, v8, 2, v89
    v_lshl_add_u32 v88, v9, 8, s49
    v_lshl_add_u32 v88, v8, 3, v88
    v_bfe_u32 v9, v0, 3, 2
    v_lshl_add_u32 v88, v9, 4, v88
    v_and_b32 v9, 1, v0
    v_lshl_add_u32 v88, v9, 2, v88
    ds_read_b32 v142, v88 offset:8320
    s_waitcnt lgkmcnt(0)
    v_lshlrev_b32 v141, 16, v142
    v_and_b32 v142, 0xffff0000, v142
    s_lshr_b32 s49, s3, 2
    s_lshl_b32 s50, s49, 7
    v_xor_b32 v91, s50, v2
    s_lshl_b32 s50, s49, 15
    s_add_u32 s50, s50, 32768
    v_add_u32 v91, s50, v91
    v_xor_b32 v92, 0x80, v91
    v_add_u32 v95, 98304, v2
    s_lshl3_add_u32 s49, s5, s3
    s_lshl_b32 s41, s49, 8
    s_lshl_b32 s100, s49, 9
    s_lshr_b32 s49, s5, 2
    s_lshl_b32 s50, s49, 5
    s_add_u32 s50, s50, s59
    s_lshl1_add_u32 s50, s50, s3
    s_lshl_b32 s98, s50, 7
    s_lshl3_add_u32 s49, s49, s4
    s_lshl2_add_u32 s49, s49, s59
    s_lshl1_add_u32 s49, s49, s3
    s_lshl_b32 s99, s49, 8
    v_lshlrev_b32 v93, 11, v152
    v_bfe_u32 v8, v0, 3, 1
    v_lshl_add_u32 v93, v8, 10, v93
    v_lshl_add_u32 v93, v5, 2, v93
    v_lshl_add_u32 v87, v154, 7, v83
    v_lshl_or_b32 v94, v8, 30, v87
    s_lshr_b32 s99, s99, 2
    s_add_u32 s99, s99, 458752
    s_lshr_b32 s100, s100, 2
    s_add_u32 s100, s100, 458752
    v_lshrrev_b32 v9, 5, v0
    v_lshlrev_b32 v9, 2, v9
    v_lshl_add_u32 v94, v5, 1, v9
    v_and_b32 v9, 24, v0
    v_lshl_or_b32 v94, v9, 26, v94
    s_lshl_b32 s49, s3, 4
    v_lshrrev_b32 v9, 1, v5
    v_add_u32 v9, s49, v9
    v_bfe_u32 v10, v0, 3, 2
    v_lshl_add_u32 v9, v153, 2, s49
    v_mov_b32 v10, v154
    v_lshrrev_b32 v87, 5, v9
    v_lshlrev_b32 v87, 8, v87
    v_bfe_u32 v14, v9, 2, 2
    v_lshl_add_u32 v87, v14, 6, v87
    v_lshl_add_u32 v87, v10, 4, v87
    v_bfe_u32 v14, v9, 4, 1
    v_lshl_add_u32 v87, v14, 3, v87
    v_and_b32 v14, 3, v9
    v_lshl_add_u32 v87, v14, 1, v87
    v_and_b32 v99, 0x7c, v1
    v_lshrrev_b32 v9, 5, v0
    v_lshl_or_b32 v99, v9, 30, v99
    v_lshlrev_b32 v9, 3, v0
    v_add_u32 v9, 1024, v9
    v_cmp_gt_u32 vcc, 16, v0
    s_nop 1
    v_cndmask_b32 v87, v9, v87, vcc
L_predone:
L_v_78:
    s_and_b32 s50, s54, 15
    s_lshl_b32 s50, s50, 13
    s_add_u32 s50, s50, 32768
    v_add_u32 v8, s50, v2
    s_add_u32 s54, s54, 1
    ds_read_b128 v[20:23], v7 offset:16384
    v_add_u32 v7, 512, v7
L_vp_79:
    ds_read_b32 v14, v1 offset:0
    ds_read_b64_tr_b16 v[16:17], v8 offset:0
    ds_read_b64_tr_b16 v[18:19], v8 offset:4096
    s_sub_u32 s48, s48, 1
    s_cbranch_scc1 L_end
    v_mov_b32 v15, s54
    s_waitcnt lgkmcnt(0)
    v_cmp_gt_i32 vcc, s54, v14
    s_cmp_lt_u32 s54, s47
    s_cbranch_vccnz L_vp_79
    v_mfma_f32_16x16x32_bf16 v[136:139], v[16:19], v[20:23], v[136:139]
    ds_write_b32 v6, v15 offset:256
    s_cbranch_scc1 L_v_78
    s_cmp_eq_u32 s37, 0
    s_nop 4
    v_mul_f32 v136, v140, v136
    v_mul_f32 v137, v140, v137
    v_mul_f32 v138, v140, v138
    v_mul_f32 v139, v140, v139
    v_bfi_b32 v136, s7, v145, v136
    v_bfi_b32 v137, s7, v145, v137
    s_cbranch_scc1 L_sg_80
    buffer_store_dwordx4 v[136:139], v80, s[12:15], s60 offen
L_sd_81:
    s_cmp_lt_u32 s2, 224
    s_cbranch_scc1 L_noo
    s_waitcnt vmcnt(0)
    buffer_load_dwordx4 v[16:19], v150, s[12:15], s61 offen offset:0 sc1
    buffer_load_dwordx4 v[20:23], v150, s[12:15], s61 offen offset:1024 sc1
    buffer_load_dwordx4 v[24:27], v150, s[12:15], s61 offen offset:2048 sc1
    buffer_load_dwordx4 v[28:31], v150, s[12:15], s61 offen offset:3072 sc1
L_g_82:
    s_waitcnt vmcnt(0)
    v_bitop3_b32 v14, v16, v17, v146 bitop3:0x7e
    v_cmp_ne_u32_sdwa s[20:21], v14, v147 src0_sel:BYTE_0 src1_sel:DWORD
    v_bitop3_b32 v15, v20, v21, v146 bitop3:0x7e
    v_cmp_ne_u32_sdwa s[22:23], v15, v147 src0_sel:BYTE_0 src1_sel:DWORD
    v_bitop3_b32 v14, v24, v25, v146 bitop3:0x7e
    v_cmp_ne_u32_sdwa s[24:25], v14, v147 src0_sel:BYTE_0 src1_sel:DWORD
    v_bitop3_b32 v15, v28, v29, v146 bitop3:0x7e
    v_cmp_ne_u32_sdwa s[26:27], v15, v147 src0_sel:BYTE_0 src1_sel:DWORD
    s_or_b64 vcc, s[20:21], s[22:23]
    s_or_b64 vcc, vcc, s[24:25]
    s_or_b64 vcc, vcc, s[26:27]
    s_cbranch_scc1 L_gr_84
    v_and_b32 v16, s45, v16
    v_and_b32 v17, s45, v17
    v_and_b32 v20, s45, v20
    v_and_b32 v21, s45, v21
    v_and_b32 v24, s45, v24
    v_and_b32 v25, s45, v25
    v_and_b32 v28, s45, v28
    v_and_b32 v29, s45, v29
    v_pk_add_f32 v[16:17], v[16:17], v[24:25]
    v_pk_add_f32 v[18:19], v[18:19], v[26:27]
    v_pk_add_f32 v[20:21], v[20:21], v[28:29]
    v_pk_add_f32 v[22:23], v[22:23], v[30:31]
    v_pk_add_f32 v[16:17], v[16:17], v[20:21]
    v_pk_add_f32 v[18:19], v[18:19], v[22:23]
    s_nop 1
    v_permlane32_swap_b32 v16, v18
    v_permlane32_swap_b32 v17, v19
    v_add_f32 v16, v16, v18
    v_add_f32 v17, v17, v19
    s_nop 1
    v_permlane16_swap_b32 v16, v17
    v_add_f32 v16, v16, v17
    v_mov_b32 v17, v16
    s_nop 1
    v_permlane16_swap_b32 v16, v17
    v_cvt_pk_bf16_f32 v16, v16, v17
    v_min_u32 v16, -2, v16
    buffer_store_dword v16, v84, s[8:11], s16 offen sc1
    s_branch L_D
L_noo:
L_iss:
    ds_read_b32 v15, v147 offset:300
    s_sub_u32 s48, s48, 1
    s_cbranch_scc1 L_end
    s_waitcnt lgkmcnt(0)
    v_cmp_eq_u32 vcc, 0, v15
    s_cbranch_vccnz L_iss
L_D:
    s_add_u32 s20, s42, s17
    s_addc_u32 s21, s43, 0
L_sg2_89:
    s_load_dwordx16 s[64:79], s[20:21], 0 glc
    s_load_dwordx16 s[80:95], s[20:21], 64 glc
    s_sub_u32 s48, s48, 1
    s_cbranch_scc1 L_end
    s_waitcnt lgkmcnt(0)
    s_max_u32 s49, s64, s80
    s_cmp_eq_u32 s49, -1
    s_cbranch_scc1 L_sg2_89
    v_writelane_b32 v48, s64, 0
    v_writelane_b32 v49, s65, 0
    v_writelane_b32 v48, s66, 1
    v_writelane_b32 v49, s67, 1
    v_writelane_b32 v48, s68, 2
    v_writelane_b32 v49, s69, 2
    v_writelane_b32 v48, s70, 3
    v_writelane_b32 v49, s71, 3
    v_writelane_b32 v48, s72, 4
    v_writelane_b32 v49, s73, 4
    v_writelane_b32 v48, s74, 5
    v_writelane_b32 v49, s75, 5
    v_writelane_b32 v48, s76, 6
    v_writelane_b32 v49, s77, 6
    v_writelane_b32 v48, s78, 7
    v_writelane_b32 v49, s79, 7
    v_writelane_b32 v48, s80, 8
    v_writelane_b32 v49, s81, 8
    v_writelane_b32 v48, s82, 9
    v_writelane_b32 v49, s83, 9
    v_writelane_b32 v48, s84, 10
    v_writelane_b32 v49, s85, 10
    v_writelane_b32 v48, s86, 11
    v_writelane_b32 v49, s87, 11
    v_writelane_b32 v48, s88, 12
    v_writelane_b32 v49, s89, 12
    v_writelane_b32 v48, s90, 13
    v_writelane_b32 v49, s91, 13
    v_writelane_b32 v48, s92, 14
    v_writelane_b32 v49, s93, 14
    v_writelane_b32 v48, s94, 15
    v_writelane_b32 v49, s95, 15
    ds_write_b64 v98, v[48:49] offset:3072
    v_mov_b32 v15, 7
    ds_write_b32 v6, v15 offset:320
L_cs_90:
    ds_read_b32 v15, v5 offset:320
    s_sub_u32 s48, s48, 1
    s_cbranch_scc1 L_end
    s_waitcnt lgkmcnt(0)
    v_cmp_gt_u32 vcc, 7, v15
    s_cbranch_vccnz L_cs_90
    ds_read_b128 v[48:51], v3 offset:3072
    ds_read_b128 v[52:55], v3 offset:3328
    ds_read_b128 v[56:59], v3 offset:3584
    ds_read_b128 v[60:63], v3 offset:3840
    s_waitcnt lgkmcnt(3)
    v_mfma_f32_16x16x32_bf16 v[136:139], v[112:115], v[48:51], 0
    s_waitcnt lgkmcnt(2)
    v_mfma_f32_16x16x32_bf16 v[136:139], v[116:119], v[52:55], v[136:139]
    s_waitcnt lgkmcnt(1)
    v_mfma_f32_16x16x32_bf16 v[136:139], v[120:123], v[56:59], v[136:139]
    s_waitcnt lgkmcnt(0)
    v_mfma_f32_16x16x32_bf16 v[136:139], v[124:127], v[60:63], v[136:139]
    v_mov_b32 v15, 83
    ds_write_b32 v6, v15 offset:256
    s_cmp_eq_u32 s37, 0
    s_nop 4
    v_bfi_b32 v136, s7, v145, v136
    v_bfi_b32 v137, s7, v145, v137
    s_cbranch_scc1 L_sg_91
    buffer_store_dwordx4 v[136:139], v4, s[12:15], s18 offen
L_sd_92:
    s_cmp_lt_u32 s2, 224
    s_cbranch_scc1 L_E
    s_waitcnt vmcnt(0)
    buffer_load_dwordx4 v[16:19], v81, s[12:15], s19 offen offset:0 sc1
    buffer_load_dwordx4 v[20:23], v82, s[12:15], s19 offen offset:0 sc1
L_g_93:
    s_waitcnt vmcnt(0)
    v_bitop3_b32 v14, v16, v17, v146 bitop3:0x7e
    v_cmp_ne_u32_sdwa s[20:21], v14, v147 src0_sel:BYTE_0 src1_sel:DWORD
    v_bitop3_b32 v15, v20, v21, v146 bitop3:0x7e
    v_cmp_ne_u32_sdwa s[22:23], v15, v147 src0_sel:BYTE_0 src1_sel:DWORD
    s_nop 0
    s_or_b64 vcc, s[20:21], s[22:23]
    s_cbranch_scc1 L_gr_95
    v_and_b32 v16, s45, v16
    v_and_b32 v17, s45, v17
    v_and_b32 v20, s45, v20
    v_and_b32 v21, s45, v21
    v_pk_add_f32 v[16:17], v[16:17], v[20:21]
    v_pk_add_f32 v[18:19], v[18:19], v[22:23]
    s_nop 1
    v_permlane32_swap_b32 v16, v18
    v_permlane32_swap_b32 v17, v19
    v_add_f32 v16, v16, v18
    v_add_f32 v17, v17, v19
    s_nop 1
    v_permlane16_swap_b32 v16, v17
    v_add_f32 v16, v16, v17
    s_nop 1
    v_add_f32_dpp v16, v16, v16 row_ror:8 row_mask:0xf bank_mask:0xf
    s_nop 1
    v_add_f32_dpp v16, v16, v16 row_ror:4 row_mask:0xf bank_mask:0xf
    v_fmac_f32 v142, v141, v16
    v_mov_b32 v16, v142
    v_mov_b32 v17, v16
    s_nop 1
    v_permlane16_swap_b32 v16, v17
    v_cvt_pk_bf16_f32 v16, v16, v17
    v_min_u32 v16, -2, v16
    buffer_store_dword v16, v89, s[8:11], s34 offen sc1
    v_cvt_pk_bf16_f32 v142, v142, v142
    v_mov_b32 v8, 1
    s_mov_b64 exec, 1
    s_waitcnt vmcnt(0)
    ds_add_rtn_u32 v9, v147, v8 offset:296
    s_mov_b64 exec, -1
    s_waitcnt lgkmcnt(0)
    v_readfirstlane_b32 s50, v9
    s_lshl2_add_u32 s49, s59, 200704
    s_add_u32 s51, s6, 13605
    s_cmp_lg_u32 s50, 7
    s_cbranch_scc1 L_norep
    v_lshlrev_b32 v8, 7, v0
    v_mov_b32 v9, s51
    s_mov_b32 exec_hi, 0
    s_cmp_eq_u32 s37, 0
    s_cbranch_scc1 L_sg_98
    buffer_store_dword v9, v8, s[12:15], s49 offen
L_sd_99:
    s_mov_b64 exec, -1
L_norep:
    s_lshl3_add_u32 s49, s2, s3
    s_cmp_lg_u32 s49, 2047
    s_cbranch_scc1 L_ep_100
    s_add_u32 s49, s6, 27210
    s_mov_b32 s50, 393216
    v_mov_b32 v8, s49
    buffer_store_dword v8, v147, s[8:11], s50 offen
L_ep_100:
    v_and_b32 v142, 0xffff0000, v142
    v_add_u32 v145, 13605, v145
    v_add_u32 v146, 13605, v146
    s_cmp_ge_u32 s61, 114688
    s_cbranch_scc1 L_nogr
    buffer_load_dwordx4 v[20:23], v93, s[12:15], s98 offen offset:1024 sc1
    buffer_load_dwordx4 v[16:19], v93, s[12:15], s98 offen offset:0 sc1
L_g_101:
    s_waitcnt vmcnt(0)
    v_bitop3_b32 v14, v20, v21, v146 bitop3:0x7e
    v_cmp_ne_u32_sdwa s[20:21], v14, v147 src0_sel:BYTE_0 src1_sel:DWORD
    v_bitop3_b32 v15, v16, v17, v146 bitop3:0x7e
    v_cmp_ne_u32_sdwa s[22:23], v15, v147 src0_sel:BYTE_0 src1_sel:DWORD
    s_nop 0
    s_or_b64 vcc, s[20:21], s[22:23]
    s_cbranch_scc1 L_gr_103
    v_and_b32 v20, s45, v20
    v_and_b32 v21, s45, v21
    v_and_b32 v16, s45, v16
    v_and_b32 v17, s45, v17
    s_nop 0
    v_permlane32_swap_b32 v16, v18
    v_permlane32_swap_b32 v17, v19
    v_permlane32_swap_b32 v20, v22
    v_permlane32_swap_b32 v21, v23
    v_add_f32 v16, v16, v18
    v_add_f32 v17, v17, v19
    v_add_f32 v20, v20, v22
    v_add_f32 v21, v21, v23
    v_permlane16_swap_b32 v16, v17
    s_nop 0
    v_permlane16_swap_b32 v20, v21
    v_add_f32 v16, v16, v17
    v_add_f32 v20, v20, v21
    v_mul_f32 v9, v16, v16
    v_mov_b32 v10, 0xc0135761
    v_fmac_f32 v10, 0xbdd2d3e8, v9
    v_mul_f32 v20, v16, v20
    v_mul_f32 v10, v10, v16
    v_exp_f32 v10, v10
    s_nop 0
    v_add_f32 v10, 1.0, v10
    v_rcp_f32 v10, v10
    s_nop 0
    v_mul_f32 v16, v20, v10
    v_mov_b32 v20, v16
    s_nop 1
    v_permlane16_swap_b32 v16, v20
    v_cvt_pk_bf16_f32 v16, v16, v20
    v_min_u32 v16, -2, v16
    buffer_store_dword v16, v84, s[8:11], s99 offen sc1
    s_waitcnt vmcnt(0)
L_nogr:
    buffer_load_dwordx4 v[16:19], v81, s[12:15], s19 offen offset:0 sc1
    buffer_load_dwordx4 v[20:23], v86, s[12:15], s19 offen offset:0 sc1
L_g_106:
    s_waitcnt vmcnt(0)
    v_bitop3_b32 v14, v16, v17, v146 bitop3:0x7e
    v_cmp_ne_u32_sdwa s[20:21], v14, v147 src0_sel:BYTE_0 src1_sel:DWORD
    v_bitop3_b32 v15, v20, v21, v146 bitop3:0x7e
    v_cmp_ne_u32_sdwa s[22:23], v15, v147 src0_sel:BYTE_0 src1_sel:DWORD
    s_nop 0
    s_or_b64 vcc, s[20:21], s[22:23]
    s_cbranch_scc1 L_gr_108
    v_and_b32 v16, s45, v16
    v_and_b32 v17, s45, v17
    v_and_b32 v20, s45, v20
    v_and_b32 v21, s45, v21
    v_fmac_f32 v16, v97, v20
    v_fmac_f32 v17, v97, v21
    v_fmac_f32 v18, v97, v22
    v_fmac_f32 v19, v97, v23
    s_nop 0
    v_permlane32_swap_b32 v16, v18
    v_permlane32_swap_b32 v17, v19
    v_add_f32 v16, v16, v18
    v_add_f32 v17, v17, v19
    s_nop 1
    v_permlane16_swap_b32 v16, v17
    v_add_f32 v16, v16, v17
    s_nop 1
    v_add_f32_dpp v16, v16, v16 row_ror:8 row_mask:0xf bank_mask:0xf
    s_nop 1
    v_add_f32_dpp v16, v16, v16 row_ror:4 row_mask:0xf bank_mask:0xf
    v_fmac_f32 v142, v143, v16
    v_cvt_pk_bf16_f32 v142, v142, v142
    s_mov_b32 exec_lo, 0x000f000f
    s_mov_b32 exec_hi, 0x000f000f
    global_store_short v96, v142, s[38:39]
    s_branch L_fin
L_E:
    s_mov_b32 s49, 200704
    s_add_u32 s51, s6, 13605
L_rh:
    s_load_dwordx4 s[20:23], s[12:13], s49
    s_add_u32 s49, s49, 128
    s_cmp_lt_u32 s49, 204800
    s_cbranch_scc0 L_nohint
    s_waitcnt lgkmcnt(0)
    s_and_b64 s[24:25], s[20:21], s[22:23]
    s_or_b64 s[20:21], s[20:21], s[22:23]
    s_and_b32 s24, s24, s25
    s_or_b32 s20, s20, s21
    s_xor_b32 s24, s24, s51
    s_xor_b32 s20, s20, s51
    s_or_b32 s20, s20, s24
    s_cbranch_scc0 L_nohint
    s_sleep 1
    s_branch L_rh
L_nohint:
    s_waitcnt lgkmcnt(0)
    buffer_load_dword v57, v1, s[8:11], s40 offen sc1
    buffer_load_dwordx4 v[48:51], v150, s[8:11], s35 offen sc1
    v_mov_b32 v15, 84
    ds_write_b32 v6, v15 offset:256
    s_lshr_b32 s49, s3, 2
    s_lshl2_add_u32 s49, s49, 82
    s_cmp_ge_i32 s53, s49
    s_cbranch_scc1 L_wd_115
L_wl_114:
    ds_read_b32 v15, v1 offset:0
    s_sub_u32 s48, s48, 1
    s_cbranch_scc1 L_end
    s_waitcnt lgkmcnt(0)
    v_readfirstlane_b32 s53, v15
    s_nop 0
    s_cmp_lt_i32 s53, s49
    s_cbranch_scc1 L_wl_114
L_wd_115:
    ds_read_b64_tr_b16 v[16:17], v91 offset:0
    ds_read_b64_tr_b16 v[18:19], v91 offset:4096
    ds_read_b64_tr_b16 v[32:33], v92 offset:0
    ds_read_b64_tr_b16 v[34:35], v92 offset:4096
    ds_read_b64_tr_b16 v[20:21], v91 offset:8192
    ds_read_b64_tr_b16 v[22:23], v91 offset:12288
    ds_read_b64_tr_b16 v[36:37], v92 offset:8192
    ds_read_b64_tr_b16 v[38:39], v92 offset:12288
L_g_111:
    s_waitcnt vmcnt(0)
    v_cmp_eq_u32 s[20:21], -1, v57
    v_cmp_eq_u32 s[22:23], -1, v48
    s_nop 0
    s_or_b64 vcc, s[20:21], s[22:23]
    s_cbranch_scc1 L_gr_113
    v_lshlrev_b32 v56, 16, v57
    v_and_b32 v57, 0xffff0000, v57
    v_dot2_f32_bf16 v8, v48, v103, 0
    v_dot2_f32_bf16 v9, v48, v48, 0
    v_mul_f32 v56, v56, v141
    v_mul_f32 v57, v57, v142
    v_dot2_f32_bf16 v8, v49, v103, v8
    v_dot2_f32_bf16 v9, v49, v49, v9
    v_dot2_f32_bf16 v8, v50, v103, v8
    v_dot2_f32_bf16 v9, v50, v50, v9
    v_dot2_f32_bf16 v8, v51, v103, v8
    v_dot2_f32_bf16 v9, v51, v51, v9
    v_cvt_pk_bf16_f32 v10, v56, v57
    ds_write_b32 v88, v10 offset:8192
    v_lshlrev_b32 v11, 16, v10
    v_permlane32_swap_b32 v8, v9
    v_and_b32 v12, 0xffff0000, v10
    v_add_f32 v8, v8, v9
    v_sub_f32 v56, v56, v11
    v_mov_b32 v9, v8
    v_sub_f32 v57, v57, v12
    v_cvt_pk_bf16_f32 v10, v56, v57
    v_permlane16_swap_b32 v8, v9
    v_add_f32 v8, v8, v9
    ds_write_b32 v88, v10 offset:8256
    s_nop 0
    v_add_f32_dpp v8, v8, v8 row_ror:8 row_mask:0xf bank_mask:0xf
    s_nop 1
    v_add_f32_dpp v8, v8, v8 quad_perm:[1,0,3,2] row_mask:0xf bank_mask:0xf
    ds_write_b32 v89, v8 offset:512
    v_mov_b32 v15, 9
    ds_write_b32 v6, v15 offset:320
    s_lshr_b32 s49, s3, 2
    s_lshl2_add_u32 s49, s49, 84
    s_cmp_ge_i32 s53, s49
    s_cbranch_scc1 L_wd_120
L_wl_119:
    ds_read_b32 v15, v1 offset:0
    s_sub_u32 s48, s48, 1
    s_cbranch_scc1 L_end
    s_waitcnt lgkmcnt(0)
    v_readfirstlane_b32 s53, v15
    s_nop 0
    s_cmp_lt_i32 s53, s49
    s_cbranch_scc1 L_wl_119
L_wd_120:
    ds_read_b64_tr_b16 v[24:25], v91 offset:16384
    ds_read_b64_tr_b16 v[26:27], v91 offset:20480
    ds_read_b64_tr_b16 v[40:41], v92 offset:16384
    ds_read_b64_tr_b16 v[42:43], v92 offset:20480
    ds_read_b64_tr_b16 v[28:29], v91 offset:24576
    ds_read_b64_tr_b16 v[30:31], v91 offset:28672
    ds_read_b64_tr_b16 v[44:45], v92 offset:24576
    ds_read_b64_tr_b16 v[46:47], v92 offset:28672
L_cs_118:
    ds_read_b32 v15, v5 offset:320
    s_sub_u32 s48, s48, 1
    s_cbranch_scc1 L_end
    s_waitcnt lgkmcnt(0)
    v_cmp_gt_u32 vcc, 9, v15
    s_cbranch_vccnz L_cs_118
    ds_read_b64 v[8:9], v90 offset:512
    ds_read_b128 v[48:51], v150 offset:8192
    ds_read_b128 v[52:55], v150 offset:9216
    ds_read_b128 v[56:59], v150 offset:10240
    ds_read_b128 v[60:63], v150 offset:11264
    ds_read_b128 v[64:67], v150 offset:12288
    ds_read_b128 v[68:71], v150 offset:13312
    ds_read_b128 v[72:75], v150 offset:14336
    ds_read_b128 v[76:79], v150 offset:15360
    s_waitcnt lgkmcnt(7)
    v_mfma_f32_16x16x32_bf16 v[136:139], v[16:19], v[48:51], 0
    v_add_f32_dpp v8, v8, v8 row_ror:4 row_mask:0xf bank_mask:0xf
    v_add_f32_dpp v9, v9, v9 row_ror:4 row_mask:0xf bank_mask:0xf
    s_waitcnt lgkmcnt(6)
    v_mfma_f32_16x16x32_bf16 v[136:139], v[20:23], v[52:55], v[136:139]
    v_add_f32_dpp v8, v8, v8 row_ror:8 row_mask:0xf bank_mask:0xf
    v_add_f32_dpp v9, v9, v9 row_ror:8 row_mask:0xf bank_mask:0xf
    s_waitcnt lgkmcnt(5)
    v_mfma_f32_16x16x32_bf16 v[136:139], v[24:27], v[56:59], v[136:139]
    v_mov_b32 v10, v8
    v_mov_b32 v11, v9
    s_waitcnt lgkmcnt(4)
    v_mfma_f32_16x16x32_bf16 v[136:139], v[28:31], v[60:63], v[136:139]
    v_permlane16_swap_b32 v8, v10
    v_permlane16_swap_b32 v9, v11
    v_add_f32 v8, v8, v10
    v_add_f32 v9, v9, v11
    s_waitcnt lgkmcnt(3)
    v_mfma_f32_16x16x32_bf16 v[136:139], v[32:35], v[64:67], v[136:139]
    v_mul_f32 v10, 0x3a800000, v8
    v_mul_f32 v9, 0x3a800000, v9
    v_fma_f32 v9, -v10, v10, v9
    s_waitcnt lgkmcnt(2)
    v_mfma_f32_16x16x32_bf16 v[136:139], v[36:39], v[68:71], v[136:139]
    v_max_f32 v9, 0, v9
    v_add_f32 v9, 0x3727c5ac, v9
    v_rsq_f32 v9, v9
    s_waitcnt lgkmcnt(1)
    v_mfma_f32_16x16x32_bf16 v[136:139], v[40:43], v[72:75], v[136:139]
    v_fma_f32 v8, v8, v101, v100
    v_fma_f32 v8, v8, v9, v102
    s_waitcnt lgkmcnt(0)
    v_mfma_f32_16x16x32_bf16 v[136:139], v[44:47], v[76:79], v[136:139]
    v_add_u32 v145, 13605, v145
    v_add_u32 v146, 13605, v146
    s_nop 5
    v_mul_f32 v136, v8, v136
    v_mul_f32 v137, v8, v137
    v_mul_f32 v138, v8, v138
    v_mul_f32 v139, v8, v139
    v_add_f32_dpp v136, v136, v136 row_ror:4 row_mask:0xf bank_mask:0xf
    v_add_f32_dpp v137, v137, v137 row_ror:4 row_mask:0xf bank_mask:0xf
    v_add_f32_dpp v138, v138, v138 row_ror:4 row_mask:0xf bank_mask:0xf
    v_add_f32_dpp v139, v139, v139 row_ror:4 row_mask:0xf bank_mask:0xf
    v_add_f32_dpp v136, v136, v136 row_ror:8 row_mask:0xf bank_mask:0xf
    v_add_f32_dpp v137, v137, v137 row_ror:8 row_mask:0xf bank_mask:0xf
    v_add_f32_dpp v138, v138, v138 row_ror:8 row_mask:0xf bank_mask:0xf
    v_add_f32_dpp v139, v139, v139 row_ror:8 row_mask:0xf bank_mask:0xf
    s_cmp_eq_u32 s37, 0
    v_bfi_b32 v136, s7, v145, v136
    v_bfi_b32 v137, s7, v145, v137
    s_cbranch_scc1 L_sg_121
    buffer_store_dwordx4 v[136:139], v4, s[12:15], s41 offen
L_sd_122:
    v_mov_b32 v15, 85
    ds_write_b32 v6, v15 offset:256
    s_waitcnt vmcnt(0)
    s_cmp_ge_i32 s53, 90
    s_cbranch_scc1 L_wd_124
L_wl_123:
    ds_read_b32 v15, v1 offset:0
    s_sub_u32 s48, s48, 1
    s_cbranch_scc1 L_end
    s_waitcnt lgkmcnt(0)
    v_readfirstlane_b32 s53, v15
    s_nop 0
    s_cmp_lt_i32 s53, 90
    s_cbranch_scc1 L_wl_123
L_wd_124:
    ds_read_b64_tr_b16 v[112:113], v95 offset:0
    ds_read_b64_tr_b16 v[114:115], v95 offset:4096
    ds_read_b64_tr_b16 v[116:117], v95 offset:8192
    ds_read_b64_tr_b16 v[118:119], v95 offset:12288
    s_add_u32 s20, s42, s100
    s_addc_u32 s21, s43, 0
L_sg2_125:
    s_load_dwordx16 s[64:79], s[20:21], 0 glc
    s_load_dwordx16 s[80:95], s[20:21], 64 glc
    s_sub_u32 s48, s48, 1
    s_cbranch_scc1 L_end
    s_waitcnt lgkmcnt(0)
    s_max_u32 s49, s64, s80
    s_cmp_eq_u32 s49, -1
    s_cbranch_scc1 L_sg2_125
    v_writelane_b32 v48, s64, 0
    v_writelane_b32 v49, s65, 0
    v_writelane_b32 v48, s66, 1
    v_writelane_b32 v49, s67, 1
    v_writelane_b32 v48, s68, 2
    v_writelane_b32 v49, s69, 2
    v_writelane_b32 v48, s70, 3
    v_writelane_b32 v49, s71, 3
    v_writelane_b32 v48, s72, 4
    v_writelane_b32 v49, s73, 4
    v_writelane_b32 v48, s74, 5
    v_writelane_b32 v49, s75, 5
    v_writelane_b32 v48, s76, 6
    v_writelane_b32 v49, s77, 6
    v_writelane_b32 v48, s78, 7
    v_writelane_b32 v49, s79, 7
    v_writelane_b32 v48, s80, 8
    v_writelane_b32 v49, s81, 8
    v_writelane_b32 v48, s82, 9
    v_writelane_b32 v49, s83, 9
    v_writelane_b32 v48, s84, 10
    v_writelane_b32 v49, s85, 10
    v_writelane_b32 v48, s86, 11
    v_writelane_b32 v49, s87, 11
    v_writelane_b32 v48, s88, 12
    v_writelane_b32 v49, s89, 12
    v_writelane_b32 v48, s90, 13
    v_writelane_b32 v49, s91, 13
    v_writelane_b32 v48, s92, 14
    v_writelane_b32 v49, s93, 14
    v_writelane_b32 v48, s94, 15
    v_writelane_b32 v49, s95, 15
    ds_write_b64 v87, v[48:49] offset:4096
    v_mov_b32 v15, 12
    ds_write_b32 v6, v15 offset:320
    s_cmp_ge_i32 s53, 92
    s_cbranch_scc1 L_wd_128
L_wl_127:
    ds_read_b32 v15, v1 offset:0
    s_sub_u32 s48, s48, 1
    s_cbranch_scc1 L_end
    s_waitcnt lgkmcnt(0)
    v_readfirstlane_b32 s53, v15
    s_nop 0
    s_cmp_lt_i32 s53, 92
    s_cbranch_scc1 L_wl_127
L_wd_128:
    ds_read_b64_tr_b16 v[120:121], v95 offset:16384
    ds_read_b64_tr_b16 v[122:123], v95 offset:20480
    ds_read_b64_tr_b16 v[124:125], v95 offset:24576
    ds_read_b64_tr_b16 v[126:127], v95 offset:28672
L_cs_126:
    ds_read_b32 v15, v5 offset:320
    s_sub_u32 s48, s48, 1
    s_cbranch_scc1 L_end
    s_waitcnt lgkmcnt(0)
    v_cmp_gt_u32 vcc, 12, v15
    s_cbranch_vccnz L_cs_126
    ds_read_b128 v[48:51], v3 offset:4096
    ds_read_b128 v[52:55], v3 offset:4352
    ds_read_b128 v[56:59], v3 offset:4608
    ds_read_b128 v[60:63], v3 offset:4864
    s_waitcnt lgkmcnt(3)
    v_mfma_f32_16x16x32_bf16 v[136:139], v[112:115], v[48:51], 0
    s_waitcnt lgkmcnt(2)
    v_mfma_f32_16x16x32_bf16 v[136:139], v[116:119], v[52:55], v[136:139]
    s_waitcnt lgkmcnt(1)
    v_mfma_f32_16x16x32_bf16 v[136:139], v[120:123], v[56:59], v[136:139]
    s_waitcnt lgkmcnt(0)
    v_mfma_f32_16x16x32_bf16 v[136:139], v[124:127], v[60:63], v[136:139]
    s_cmp_eq_u32 s37, 0
    s_nop 6
    v_bfi_b32 v136, s7, v145, v136
    v_bfi_b32 v137, s7, v145, v137
    s_cbranch_scc1 L_sg_129
    buffer_store_dwordx4 v[136:139], v4, s[12:15], s18 offen
L_sd_130:
L_fin:
L_end:
    s_endpgm
L_sg_8:
    buffer_store_dwordx4 v[136:139], v4, s[12:15], s50 offen sc1
    s_branch L_sd_9
L_gr_15:
    s_sub_u32 s48, s48, 1
    s_cbranch_scc1 L_end
    s_sleep 2
    s_wqm_b64 exec, s[20:21]
    s_cbranch_execz L_gn_16
    buffer_load_dwordx4 v[16:19], v150, s[12:15], s50 offen offset:0 sc1
L_gn_16:
    s_wqm_b64 exec, s[22:23]
    s_cbranch_execz L_gn_17
    buffer_load_dwordx4 v[20:23], v150, s[12:15], s51 offen offset:0 sc1
L_gn_17:
    s_mov_b64 exec, -1
    s_branch L_g_13
L_gr_20:
    s_sub_u32 s48, s48, 1
    s_cbranch_scc1 L_end
    s_sleep 8
    s_wqm_b64 exec, s[20:21]
    s_cbranch_execz L_gn_21
    buffer_load_dwordx4 v[16:19], v150, s[12:15], s50 offen offset:0 sc1
L_gn_21:
    s_wqm_b64 exec, s[22:23]
    s_cbranch_execz L_gn_22
    buffer_load_dwordx4 v[20:23], v150, s[12:15], s51 offen offset:0 sc1
L_gn_22:
    s_mov_b64 exec, -1
    s_branch L_g_18
L_gr_25:
    s_sub_u32 s48, s48, 1
    s_cbranch_scc1 L_end
    s_sleep 8
    s_wqm_b64 exec, s[20:21]
    s_cbranch_execz L_gn_26
    buffer_load_dwordx4 v[16:19], v9, s[12:15], s51 offen offset:0 sc1
L_gn_26:
    s_wqm_b64 exec, s[22:23]
    s_cbranch_execz L_gn_27
    buffer_load_dwordx4 v[20:23], v9, s[12:15], s52 offen offset:0 sc1
L_gn_27:
    s_mov_b64 exec, -1
    s_branch L_g_23
L_gr_34:
    s_sub_u32 s48, s48, 1
    s_cbranch_scc1 L_end
    s_sleep 8
    s_wqm_b64 exec, vcc
    buffer_load_dword v80, v156, s[8:11], s50 offen offset:0 sc1
L_gn_35:
    s_mov_b64 exec, -1
    s_branch L_g_32
L_sg_37:
    buffer_store_dwordx4 v[136:139], v4, s[12:15], s51 offen sc1
    s_branch L_sd_38
L_gr_43:
    s_sub_u32 s48, s48, 1
    s_cbranch_scc1 L_end
    s_sleep 2
    s_wqm_b64 exec, s[20:21]
    s_cbranch_execz L_gn_44
    buffer_load_dwordx4 v[80:83], v150, s[12:15], s50 offen offset:0 sc1
L_gn_44:
    s_wqm_b64 exec, s[22:23]
    s_cbranch_execz L_gn_45
    buffer_load_dwordx4 v[84:87], v150, s[12:15], s50 offen offset:1024 sc1
L_gn_45:
    s_mov_b64 exec, -1
    s_branch L_g_41
L_gr_52:
    s_sub_u32 s48, s48, 1
    s_cbranch_scc1 L_end
    s_sleep 8
    s_wqm_b64 exec, s[20:21]
    s_cbranch_execz L_gn_53
    buffer_load_dword v128, v10, s[8:11], s49 offen offset:0 sc1
L_gn_53:
    s_wqm_b64 exec, s[22:23]
    s_cbranch_execz L_gn_54
    buffer_load_dword v129, v10, s[8:11], s49 offen offset:256 sc1
L_gn_54:
    s_mov_b64 exec, -1
    s_branch L_g_50
L_sg_60:
    buffer_store_dwordx2 v[80:81], v8, s[12:15], s49 offen sc1
    s_branch L_sd_61
L_gr_68:
    s_sub_u32 s48, s48, 1
    s_cbranch_scc1 L_end
    s_sleep 8
    s_wqm_b64 exec, s[20:21]
    s_cbranch_execz L_gn_69
    buffer_load_dwordx2 v[24:25], v8, s[12:15], s49 offen sc1
L_gn_69:
    s_wqm_b64 exec, s[22:23]
    s_cbranch_execz L_gn_70
    buffer_load_dwordx2 v[26:27], v8, s[12:15], s49 offen offset:512 sc1
L_gn_70:
    s_wqm_b64 exec, s[24:25]
    s_cbranch_execz L_gn_71
    buffer_load_dwordx2 v[48:49], v8, s[8:11], s51 offen offset:0 sc1
L_gn_71:
    s_wqm_b64 exec, s[26:27]
    s_cbranch_execz L_gn_72
    buffer_load_dwordx2 v[50:51], v8, s[8:11], s51 offen offset:512 sc1
L_gn_72:
    s_mov_b64 exec, -1
    s_branch L_g_66
L_gr_75:
    s_sub_u32 s48, s48, 1
    s_cbranch_scc1 L_end
    s_sleep 8
    s_wqm_b64 exec, s[20:21]
    s_cbranch_execz L_gn_76
    buffer_load_dwordx2 v[24:25], v8, s[12:15], s49 offen sc1
L_gn_76:
    s_wqm_b64 exec, s[22:23]
    s_cbranch_execz L_gn_77
    buffer_load_dwordx2 v[26:27], v8, s[12:15], s49 offen offset:512 sc1
L_gn_77:
    s_mov_b64 exec, -1
    s_branch L_g_73
L_sg_80:
    buffer_store_dwordx4 v[136:139], v80, s[12:15], s60 offen sc1
    s_branch L_sd_81
L_gr_84:
    s_sub_u32 s48, s48, 1
    s_cbranch_scc1 L_end
    s_wqm_b64 exec, s[20:21]
    s_cbranch_execz L_gn_85
    buffer_load_dwordx4 v[16:19], v150, s[12:15], s61 offen offset:0 sc1
L_gn_85:
    s_wqm_b64 exec, s[22:23]
    s_cbranch_execz L_gn_86
    buffer_load_dwordx4 v[20:23], v150, s[12:15], s61 offen offset:1024 sc1
L_gn_86:
    s_wqm_b64 exec, s[24:25]
    s_cbranch_execz L_gn_87
    buffer_load_dwordx4 v[24:27], v150, s[12:15], s61 offen offset:2048 sc1
L_gn_87:
    s_wqm_b64 exec, s[26:27]
    s_cbranch_execz L_gn_88
    buffer_load_dwordx4 v[28:31], v150, s[12:15], s61 offen offset:3072 sc1
L_gn_88:
    s_mov_b64 exec, -1
    s_branch L_g_82
L_sg_91:
    buffer_store_dwordx4 v[136:139], v4, s[12:15], s18 offen sc1
    s_branch L_sd_92
L_gr_95:
    s_sub_u32 s48, s48, 1
    s_cbranch_scc1 L_end
    s_wqm_b64 exec, s[20:21]
    s_cbranch_execz L_gn_96
    buffer_load_dwordx4 v[16:19], v81, s[12:15], s19 offen offset:0 sc1
L_gn_96:
    s_wqm_b64 exec, s[22:23]
    s_cbranch_execz L_gn_97
    buffer_load_dwordx4 v[20:23], v82, s[12:15], s19 offen offset:0 sc1
L_gn_97:
    s_mov_b64 exec, -1
    s_branch L_g_93
L_sg_98:
    buffer_store_dword v9, v8, s[12:15], s49 offen sc1
    s_branch L_sd_99
L_gr_103:
    s_sub_u32 s48, s48, 1
    s_cbranch_scc1 L_end
    s_wqm_b64 exec, s[20:21]
    s_cbranch_execz L_gn_104
    buffer_load_dwordx4 v[20:23], v93, s[12:15], s98 offen offset:1024 sc1
L_gn_104:
    s_wqm_b64 exec, s[22:23]
    s_cbranch_execz L_gn_105
    buffer_load_dwordx4 v[16:19], v93, s[12:15], s98 offen offset:0 sc1
L_gn_105:
    s_mov_b64 exec, -1
    s_branch L_g_101
L_gr_108:
    s_sub_u32 s48, s48, 1
    s_cbranch_scc1 L_end
    s_wqm_b64 exec, s[20:21]
    s_cbranch_execz L_gn_109
    buffer_load_dwordx4 v[16:19], v81, s[12:15], s19 offen offset:0 sc1
L_gn_109:
    s_wqm_b64 exec, s[22:23]
    s_cbranch_execz L_gn_110
    buffer_load_dwordx4 v[20:23], v86, s[12:15], s19 offen offset:0 sc1
L_gn_110:
    s_mov_b64 exec, -1
    s_branch L_g_106
L_gr_113:
    s_sub_u32 s48, s48, 1
    s_cbranch_scc1 L_end
    s_wqm_b64 exec, s[20:21]
    s_cbranch_execz L_gn_116
    buffer_load_dword v57, v1, s[8:11], s40 offen sc1
L_gn_116:
    s_wqm_b64 exec, s[22:23]
    s_cbranch_execz L_gn_117
    buffer_load_dwordx4 v[48:51], v150, s[8:11], s35 offen sc1
L_gn_117:
    s_mov_b64 exec, -1
    s_branch L_g_111
L_sg_121:
    buffer_store_dwordx4 v[136:139], v4, s[12:15], s41 offen sc1
    s_branch L_sd_122
L_sg_129:
    buffer_store_dwordx4 v[136:139], v4, s[12:15], s18 offen sc1
    s_branch L_sd_130
L_last:
    s_endpgm
.section .rodata,"a"
.p2align 6
.amdhsa_kernel adaLN_cond__gqa_block_cached__geglu_ffn__decode_kernel
  .amdhsa_next_free_vgpr 160
  .amdhsa_next_free_sgpr 102
  .amdhsa_accum_offset 160
  .amdhsa_group_segment_fixed_size 0
  .amdhsa_kernarg_size 112
  .amdhsa_user_sgpr_count 2
  .amdhsa_user_sgpr_kernarg_segment_ptr 1
  .amdhsa_system_sgpr_workgroup_id_x 1
.end_amdhsa_kernel
```
